```python
import torch

def _softmax(x, axis=-1):
    return torch.softmax(x, dim=axis)
def _gelu(x):
    return torch.nn.functional.gelu(x, approximate="tanh")
def _silu(x):
    return torch.nn.functional.silu(x)
def _sigmoid(x):
    return torch.sigmoid(x)
def _layernorm(x, axis=-1, eps=1e-5):
    m = x.mean(dim=axis, keepdim=True)
    v = x.var(dim=axis, keepdim=True, unbiased=False)
    return (x - m) / torch.sqrt(v + eps)
def _scatter_add(tgt, idx, src, axis=0):
    return tgt.clone().index_add_(axis, idx, src)
def _segment_sum(src, seg, n):
    out = torch.zeros((n,) + src.shape[1:], dtype=src.dtype)
    return out.index_add_(0, seg, src)
def _pad(x, pw):
    flat = tuple(v for pair in reversed(pw) for v in pair)
    return torch.nn.functional.pad(x, flat)

kernel_name = 'gather_scatter__edge_featured_mpnn_gatedgcn__graph'

def setup_inputs():

    _w = (lambda a: (lambda t: t.to(torch.bfloat16) if t.is_floating_point() else t)(torch.as_tensor(a)))
    N, deg, D, De = 50000, 16, 64, max(4, 1)
    E = N * deg
    return {
        "x": _w((lambda *s: torch.randn(*s, dtype=torch.bfloat16) * 0.4)(N, D)),
        "e_attr": _w((lambda *s: torch.randn(*s, dtype=torch.bfloat16) * 0.8)(E, De)),
        "src": _w((lambda lo, hi, *s: torch.randint(lo, hi, s))(0, N, E).to(torch.int64)),
        "dst": _w((lambda lo, hi, *s: torch.randint(lo, hi, s))(0, N, E).to(torch.int64)),
        "w_a": _w((lambda *s: torch.randn(*s, dtype=torch.bfloat16) * 0.8)(D, D)),
        "w_b": _w((lambda *s: torch.randn(*s, dtype=torch.bfloat16) * 0.4)(D, D)),
        "w_c": _w((lambda *s: torch.randn(*s, dtype=torch.bfloat16) * 0.8)(De, D)),
        "w_u": _w((lambda *s: torch.randn(*s, dtype=torch.bfloat16) * 0.05)(D, D)),
        "w_v": _w((lambda *s: torch.randn(*s, dtype=torch.bfloat16) * 0.05)(D, D)),
    }

def reference(x, e_attr, src, dst, w_a, w_b, w_c, w_u, w_v):
    N, D = x.shape
    hv = x @ w_v
    g = x[dst] @ w_a + x[src] @ w_b + e_attr @ w_c
    eta = _sigmoid(g)
    denom = _segment_sum(eta, dst, N) + 1e-6
    eta_n = eta / denom[dst]
    agg = _segment_sum(eta_n * hv[src], dst, N)
    z = x @ w_u + agg
    relu_z = torch.where(z > 0, z, 0 * z)
    return x + relu_z
```

```asm
; @launch kernel=gs_partition_kernel grid=(251,1,1) block=(512,1,1) lds=71424
; @launch kernel=gs_main_kernel grid=(250,1,1) block=(512,1,1) lds=141312
.amdgcn_target "amdgcn-amd-amdhsa--gfx950"
.text
.globl gs_partition_kernel
.p2align 8
.type gs_partition_kernel,@function
gs_partition_kernel:
    s_load_dwordx4 s[4:7], s[0:1], 8
    s_load_dwordx2 s[8:9], s[0:1], 24
    s_load_dwordx2 s[10:11], s[0:1], 88
    s_cmp_gt_u32 s2, 250
    s_cbranch_scc1 L_part_end
    s_waitcnt lgkmcnt(0)
    s_cmp_eq_u32 s2, 250
    s_cbranch_scc1 L_part_weights
    s_mov_b32 s12, s4
    s_mov_b32 s13, s5
    s_mov_b32 s14, 0x61a800
    s_mov_b32 s15, 0x00020000
    s_mov_b32 s16, s6
    s_mov_b32 s17, s7
    s_mov_b32 s18, 0x30d400
    s_mov_b32 s19, 0x00020000
    s_mov_b32 s20, s8
    s_mov_b32 s21, s9
    s_mov_b32 s22, 0x30d400
    s_mov_b32 s23, 0x00020000
    s_add_u32 s24, s10, 0x1f8480
    s_addc_u32 s25, s11, 0
    s_mov_b32 s26, 0x927c00
    s_mov_b32 s27, 0x00020000
    s_add_u32 s28, s10, 0x10000
    s_addc_u32 s29, s11, 0
    s_mov_b32 s30, 0x1e8480
    s_mov_b32 s31, 0x00020000
    s_mul_i32 s33, s2, 12800
    s_add_u32 s34, s33, 8192
    s_lshl_b32 s35, s33, 1
    s_add_u32 s36, s35, 16384
    s_mov_b32 s37, 0xa3d70a4
    v_lshrrev_b32 v2, 6, v0
    v_and_b32 v1, 63, v0
    v_lshlrev_b32 v4, 12, v2
    v_readfirstlane_b32 s32, v2
    v_lshlrev_b32 v40, 4, v0
    v_lshlrev_b32 v41, 5, v0
    buffer_load_dwordx4 v[8:11], v40, s[20:23], s33 offen
    buffer_load_dwordx4 v[16:19], v40, s[16:19], s33 offen
    buffer_load_dwordx4 v[24:27], v41, s[12:15], s35 offen
    buffer_load_dwordx4 v[28:31], v41, s[12:15], s35 offen offset:16
    v_cmp_gt_u32 vcc, 288, v0
    s_and_saveexec_b64 s[40:41], vcc
    s_cbranch_execz L_part_sk_1
    buffer_load_dwordx4 v[12:15], v40, s[20:23], s34 offen
    buffer_load_dwordx4 v[20:23], v40, s[16:19], s34 offen
    buffer_load_dwordx4 v[32:35], v41, s[12:15], s36 offen
    buffer_load_dwordx4 v[36:39], v41, s[12:15], s36 offen offset:16
L_part_sk_1:
    s_mov_b64 exec, s[40:41]
    v_mov_b32 v44, 0
    v_mov_b32 v45, 0
    v_mov_b32 v46, 0
    v_mov_b32 v47, 0
    v_lshlrev_b32 v48, 6, v0
    ds_write_b128 v48, v[44:47] offset:0
    ds_write_b128 v48, v[44:47] offset:16
    ds_write_b128 v48, v[44:47] offset:32
    ds_write_b128 v48, v[44:47] offset:48
    s_waitcnt vmcnt(0)
    v_mul_hi_u32 v2, v8, s37
    v_mul_u32_u24 v3, 25, v2
    v_sub_u32 v65, v8, v3
    v_and_b32 v3, 7, v2
    v_lshl_or_b32 v65, v3, 5, v65
    v_and_b32 v3, 1, v2
    v_lshlrev_b32 v57, 4, v3
    v_and_b32 v2, -2, v2
    v_lshl_add_u32 v49, v2, 1, v4
    v_lshlrev_b32_e64 v81, v57, 1
    ds_add_rtn_u32 v73, v49, v81
    v_mul_hi_u32 v2, v9, s37
    v_mul_u32_u24 v3, 25, v2
    v_sub_u32 v66, v9, v3
    v_and_b32 v3, 7, v2
    v_lshl_or_b32 v66, v3, 5, v66
    v_and_b32 v3, 1, v2
    v_lshlrev_b32 v58, 4, v3
    v_and_b32 v2, -2, v2
    v_lshl_add_u32 v50, v2, 1, v4
    v_lshlrev_b32_e64 v81, v58, 1
    ds_add_rtn_u32 v74, v50, v81
    v_mul_hi_u32 v2, v10, s37
    v_mul_u32_u24 v3, 25, v2
    v_sub_u32 v67, v10, v3
    v_and_b32 v3, 7, v2
    v_lshl_or_b32 v67, v3, 5, v67
    v_and_b32 v3, 1, v2
    v_lshlrev_b32 v59, 4, v3
    v_and_b32 v2, -2, v2
    v_lshl_add_u32 v51, v2, 1, v4
    v_lshlrev_b32_e64 v81, v59, 1
    ds_add_rtn_u32 v75, v51, v81
    v_mul_hi_u32 v2, v11, s37
    v_mul_u32_u24 v3, 25, v2
    v_sub_u32 v68, v11, v3
    v_and_b32 v3, 7, v2
    v_lshl_or_b32 v68, v3, 5, v68
    v_and_b32 v3, 1, v2
    v_lshlrev_b32 v60, 4, v3
    v_and_b32 v2, -2, v2
    v_lshl_add_u32 v52, v2, 1, v4
    v_lshlrev_b32_e64 v81, v60, 1
    ds_add_rtn_u32 v76, v52, v81
    v_cmp_gt_u32 vcc, 288, v0
    s_and_saveexec_b64 s[40:41], vcc
    s_cbranch_execz L_part_sk_2
    v_mul_hi_u32 v2, v12, s37
    v_mul_u32_u24 v3, 25, v2
    v_sub_u32 v69, v12, v3
    v_and_b32 v3, 7, v2
    v_lshl_or_b32 v69, v3, 5, v69
    v_and_b32 v3, 1, v2
    v_lshlrev_b32 v61, 4, v3
    v_and_b32 v2, -2, v2
    v_lshl_add_u32 v53, v2, 1, v4
    v_lshlrev_b32_e64 v81, v61, 1
    ds_add_rtn_u32 v77, v53, v81
    v_mul_hi_u32 v2, v13, s37
    v_mul_u32_u24 v3, 25, v2
    v_sub_u32 v70, v13, v3
    v_and_b32 v3, 7, v2
    v_lshl_or_b32 v70, v3, 5, v70
    v_and_b32 v3, 1, v2
    v_lshlrev_b32 v62, 4, v3
    v_and_b32 v2, -2, v2
    v_lshl_add_u32 v54, v2, 1, v4
    v_lshlrev_b32_e64 v81, v62, 1
    ds_add_rtn_u32 v78, v54, v81
    v_mul_hi_u32 v2, v14, s37
    v_mul_u32_u24 v3, 25, v2
    v_sub_u32 v71, v14, v3
    v_and_b32 v3, 7, v2
    v_lshl_or_b32 v71, v3, 5, v71
    v_and_b32 v3, 1, v2
    v_lshlrev_b32 v63, 4, v3
    v_and_b32 v2, -2, v2
    v_lshl_add_u32 v55, v2, 1, v4
    v_lshlrev_b32_e64 v81, v63, 1
    ds_add_rtn_u32 v79, v55, v81
    v_mul_hi_u32 v2, v15, s37
    v_mul_u32_u24 v3, 25, v2
    v_sub_u32 v72, v15, v3
    v_and_b32 v3, 7, v2
    v_lshl_or_b32 v72, v3, 5, v72
    v_and_b32 v3, 1, v2
    v_lshlrev_b32 v64, 4, v3
    v_and_b32 v2, -2, v2
    v_lshl_add_u32 v56, v2, 1, v4
    v_lshlrev_b32_e64 v81, v64, 1
    ds_add_rtn_u32 v80, v56, v81
L_part_sk_2:
    s_mov_b64 exec, s[40:41]
    s_waitcnt lgkmcnt(0)
    v_lshrrev_b32 v73, v57, v73
    v_and_b32 v73, 0xffff, v73
    v_lshrrev_b32 v74, v58, v74
    v_and_b32 v74, 0xffff, v74
    v_lshrrev_b32 v75, v59, v75
    v_and_b32 v75, 0xffff, v75
    v_lshrrev_b32 v76, v60, v76
    v_and_b32 v76, 0xffff, v76
    v_lshrrev_b32 v77, v61, v77
    v_and_b32 v77, 0xffff, v77
    v_lshrrev_b32 v78, v62, v78
    v_and_b32 v78, 0xffff, v78
    v_lshrrev_b32 v79, v63, v79
    v_and_b32 v79, 0xffff, v79
    v_lshrrev_b32 v80, v64, v80
    v_and_b32 v80, 0xffff, v80
    s_barrier
    v_lshlrev_b32 v98, 3, v0
    ds_read_b64 v[82:83], v98 offset:0
    ds_read_b64 v[84:85], v98 offset:4096
    ds_read_b64 v[86:87], v98 offset:8192
    ds_read_b64 v[88:89], v98 offset:12288
    ds_read_b64 v[90:91], v98 offset:16384
    ds_read_b64 v[92:93], v98 offset:20480
    ds_read_b64 v[94:95], v98 offset:24576
    ds_read_b64 v[96:97], v98 offset:28672
    s_waitcnt lgkmcnt(0)
    v_mov_b32 v100, 0
    v_mov_b32 v101, 0
    v_add_u32 v102, v100, v82
    v_add_u32 v103, v101, v83
    v_add_u32 v104, v102, v84
    v_add_u32 v105, v103, v85
    v_add_u32 v106, v104, v86
    v_add_u32 v107, v105, v87
    v_add_u32 v108, v106, v88
    v_add_u32 v109, v107, v89
    v_add_u32 v110, v108, v90
    v_add_u32 v111, v109, v91
    v_add_u32 v112, v110, v92
    v_add_u32 v113, v111, v93
    v_add_u32 v114, v112, v94
    v_add_u32 v115, v113, v95
    v_add_u32 v116, v114, v96
    v_add_u32 v117, v115, v97
    v_and_b32 v120, 0xffff, v116
    v_lshrrev_b32 v121, 16, v116
    v_and_b32 v122, 0xffff, v117
    v_lshrrev_b32 v123, 16, v117
    v_add3_u32 v129, v120, v121, v122
    v_add_u32 v129, v129, v123
    v_mov_b32 v128, v129
    s_nop 1
    v_add_u32_dpp v128, v128, v128 row_shr:1 row_mask:0xf bank_mask:0xf bound_ctrl:0
    s_nop 1
    v_add_u32_dpp v128, v128, v128 row_shr:2 row_mask:0xf bank_mask:0xf bound_ctrl:0
    s_nop 1
    v_add_u32_dpp v128, v128, v128 row_shr:4 row_mask:0xf bank_mask:0xf bound_ctrl:0
    s_nop 1
    v_add_u32_dpp v128, v128, v128 row_shr:8 row_mask:0xf bank_mask:0xf bound_ctrl:0
    s_nop 1
    v_add_u32_dpp v128, v128, v128 row_bcast:15 row_mask:0xa bank_mask:0xf
    s_nop 1
    v_add_u32_dpp v128, v128, v128 row_bcast:31 row_mask:0xc bank_mask:0xf
    s_nop 1
    v_readlane_b32 s38, v128, 63
    v_sub_u32 v128, v128, v129
    s_lshl_b32 s39, s32, 2
    v_mov_b32 v2, s38
    v_mov_b32 v3, s39
    ds_write_b32 v3, v2 offset:32768
    s_waitcnt lgkmcnt(0)
    s_barrier
    v_mov_b32 v2, 0
    ds_read_b128 v[132:135], v2 offset:32768
    ds_read_b128 v[136:139], v2 offset:32784
    s_waitcnt lgkmcnt(0)
    s_cmp_gt_u32 s32, 0
    s_cselect_b32 s38, -1, 0
    v_and_b32 v2, s38, v132
    v_add_u32 v128, v128, v2
    s_cmp_gt_u32 s32, 1
    s_cselect_b32 s38, -1, 0
    v_and_b32 v2, s38, v133
    v_add_u32 v128, v128, v2
    s_cmp_gt_u32 s32, 2
    s_cselect_b32 s38, -1, 0
    v_and_b32 v2, s38, v134
    v_add_u32 v128, v128, v2
    s_cmp_gt_u32 s32, 3
    s_cselect_b32 s38, -1, 0
    v_and_b32 v2, s38, v135
    v_add_u32 v128, v128, v2
    s_cmp_gt_u32 s32, 4
    s_cselect_b32 s38, -1, 0
    v_and_b32 v2, s38, v136
    v_add_u32 v128, v128, v2
    s_cmp_gt_u32 s32, 5
    s_cselect_b32 s38, -1, 0
    v_and_b32 v2, s38, v137
    v_add_u32 v128, v128, v2
    s_cmp_gt_u32 s32, 6
    s_cselect_b32 s38, -1, 0
    v_and_b32 v2, s38, v138
    v_add_u32 v128, v128, v2
    v_mov_b32 v124, v128
    v_add_u32 v125, v124, v120
    v_add_u32 v126, v125, v121
    v_add_u32 v127, v126, v122
    v_lshl_or_b32 v140, v120, 16, v124
    v_lshl_or_b32 v141, v121, 16, v125
    v_lshl_or_b32 v142, v122, 16, v126
    v_lshl_or_b32 v143, v123, 16, v127
    v_lshrrev_b32 v2, 1, v0
    v_mul_u32_u24 v2, 8000, v2
    v_and_b32 v3, 1, v0
    v_lshl_add_u32 v2, v3, 4, v2
    s_mul_i32 s38, s2, 32
    buffer_store_dwordx4 v[140:143], v2, s[28:31], s38 offen sc1
    v_lshl_or_b32 v144, v125, 16, v124
    v_lshl_or_b32 v145, v127, 16, v126
    v_add_u32 v100, v100, v144
    v_add_u32 v101, v101, v145
    ds_write_b64 v98, v[100:101] offset:0
    v_add_u32 v102, v102, v144
    v_add_u32 v103, v103, v145
    ds_write_b64 v98, v[102:103] offset:4096
    v_add_u32 v104, v104, v144
    v_add_u32 v105, v105, v145
    ds_write_b64 v98, v[104:105] offset:8192
    v_add_u32 v106, v106, v144
    v_add_u32 v107, v107, v145
    ds_write_b64 v98, v[106:107] offset:12288
    v_add_u32 v108, v108, v144
    v_add_u32 v109, v109, v145
    ds_write_b64 v98, v[108:109] offset:16384
    v_add_u32 v110, v110, v144
    v_add_u32 v111, v111, v145
    ds_write_b64 v98, v[110:111] offset:20480
    v_add_u32 v112, v112, v144
    v_add_u32 v113, v113, v145
    ds_write_b64 v98, v[112:113] offset:24576
    v_add_u32 v114, v114, v144
    v_add_u32 v115, v115, v145
    ds_write_b64 v98, v[114:115] offset:28672
    s_waitcnt lgkmcnt(0)
    s_barrier
    v_lshrrev_b32 v2, 3, v57
    v_add_u32 v2, v49, v2
    ds_read_u16 v146, v2
    v_lshrrev_b32 v2, 3, v58
    v_add_u32 v2, v50, v2
    ds_read_u16 v147, v2
    v_lshrrev_b32 v2, 3, v59
    v_add_u32 v2, v51, v2
    ds_read_u16 v148, v2
    v_lshrrev_b32 v2, 3, v60
    v_add_u32 v2, v52, v2
    ds_read_u16 v149, v2
    s_waitcnt lgkmcnt(0)
    v_add_u32 v146, v146, v73
    v_mul_u32_u24 v146, 12, v146
    v_lshl_or_b32 v65, v65, 16, v16
    ds_write_b32 v146, v24 offset:33024
    ds_write_b32 v146, v25 offset:33028
    ds_write_b32 v146, v65 offset:33032
    v_add_u32 v147, v147, v74
    v_mul_u32_u24 v147, 12, v147
    v_lshl_or_b32 v66, v66, 16, v17
    ds_write_b32 v147, v26 offset:33024
    ds_write_b32 v147, v27 offset:33028
    ds_write_b32 v147, v66 offset:33032
    v_add_u32 v148, v148, v75
    v_mul_u32_u24 v148, 12, v148
    v_lshl_or_b32 v67, v67, 16, v18
    ds_write_b32 v148, v28 offset:33024
    ds_write_b32 v148, v29 offset:33028
    ds_write_b32 v148, v67 offset:33032
    v_add_u32 v149, v149, v76
    v_mul_u32_u24 v149, 12, v149
    v_lshl_or_b32 v68, v68, 16, v19
    ds_write_b32 v149, v30 offset:33024
    ds_write_b32 v149, v31 offset:33028
    ds_write_b32 v149, v68 offset:33032
    v_cmp_gt_u32 vcc, 288, v0
    s_and_saveexec_b64 s[40:41], vcc
    s_cbranch_execz L_part_sk_3
    s_nop 1
    v_lshrrev_b32 v2, 3, v61
    v_add_u32 v2, v53, v2
    ds_read_u16 v150, v2
    v_lshrrev_b32 v2, 3, v62
    v_add_u32 v2, v54, v2
    ds_read_u16 v151, v2
    v_lshrrev_b32 v2, 3, v63
    v_add_u32 v2, v55, v2
    ds_read_u16 v152, v2
    v_lshrrev_b32 v2, 3, v64
    v_add_u32 v2, v56, v2
    ds_read_u16 v153, v2
    s_waitcnt lgkmcnt(0)
    v_add_u32 v150, v150, v77
    v_mul_u32_u24 v150, 12, v150
    v_lshl_or_b32 v69, v69, 16, v20
    ds_write_b32 v150, v32 offset:33024
    ds_write_b32 v150, v33 offset:33028
    ds_write_b32 v150, v69 offset:33032
    v_add_u32 v151, v151, v78
    v_mul_u32_u24 v151, 12, v151
    v_lshl_or_b32 v70, v70, 16, v21
    ds_write_b32 v151, v34 offset:33024
    ds_write_b32 v151, v35 offset:33028
    ds_write_b32 v151, v70 offset:33032
    v_add_u32 v152, v152, v79
    v_mul_u32_u24 v152, 12, v152
    v_lshl_or_b32 v71, v71, 16, v22
    ds_write_b32 v152, v36 offset:33024
    ds_write_b32 v152, v37 offset:33028
    ds_write_b32 v152, v71 offset:33032
    v_add_u32 v153, v153, v80
    v_mul_u32_u24 v153, 12, v153
    v_lshl_or_b32 v72, v72, 16, v23
    ds_write_b32 v153, v38 offset:33024
    ds_write_b32 v153, v39 offset:33028
    ds_write_b32 v153, v72 offset:33032
L_part_sk_3:
    s_mov_b64 exec, s[40:41]
    s_waitcnt lgkmcnt(0)
    s_barrier
    s_mul_i32 s38, s2, 38400
    ds_read_b128 v[156:159], v40 offset:33024
    ds_read_b128 v[160:163], v40 offset:41216
    ds_read_b128 v[164:167], v40 offset:49408
    ds_read_b128 v[168:171], v40 offset:57600
    s_waitcnt lgkmcnt(0)
    buffer_store_dwordx4 v[156:159], v40, s[24:27], s38 offen sc1
    s_add_u32 s38, s38, 8192
    buffer_store_dwordx4 v[160:163], v40, s[24:27], s38 offen sc1
    s_add_u32 s38, s38, 8192
    buffer_store_dwordx4 v[164:167], v40, s[24:27], s38 offen sc1
    s_add_u32 s38, s38, 8192
    buffer_store_dwordx4 v[168:171], v40, s[24:27], s38 offen sc1
    s_add_u32 s38, s38, 8192
    v_cmp_gt_u32 vcc, 352, v0
    s_and_saveexec_b64 s[40:41], vcc
    s_cbranch_execz L_part_end
    v_add_u32 v2, 32768, v40
    ds_read_b128 v[172:175], v2 offset:33024
    s_waitcnt lgkmcnt(0)
    buffer_store_dwordx4 v[172:175], v40, s[24:27], s38 offen sc1
    s_branch L_part_end
L_part_weights:
    s_load_dwordx4 s[12:15], s[0:1], 32
    s_load_dwordx2 s[16:17], s[0:1], 48
    s_load_dwordx4 s[20:23], s[0:1], 56
    s_waitcnt lgkmcnt(0)
    s_mov_b32 s24, s10
    s_mov_b32 s25, s11
    s_mov_b32 s26, 0x10000
    s_mov_b32 s27, 0x00020000
    v_and_b32 v1, 63, v0
    v_and_b32 v2, 31, v0
    v_bfe_u32 v3, v0, 5, 1
    v_lshrrev_b32 v6, 6, v0
    s_nop 0
    v_readfirstlane_b32 s32, v6
    s_and_b32 s33, s32, 1
    s_lshr_b32 s34, s32, 1
    v_lshlrev_b32 v4, 2, v2
    v_lshl_add_u32 v4, v3, 10, v4
    s_lshl_b32 s35, s34, 11
    s_lshl_b32 s36, s33, 1
    s_add_u32 s35, s35, s36
    v_lshlrev_b32 v5, 4, v1
    s_mov_b32 s28, s14
    s_mov_b32 s29, s15
    s_mov_b32 s30, 0x2000
    s_mov_b32 s31, 0x00020000
    buffer_load_ushort v7, v4, s[28:31], s35 offen offset:0
    buffer_load_ushort v8, v4, s[28:31], s35 offen offset:128
    buffer_load_ushort v9, v4, s[28:31], s35 offen offset:256
    buffer_load_ushort v10, v4, s[28:31], s35 offen offset:384
    buffer_load_ushort v11, v4, s[28:31], s35 offen offset:512
    buffer_load_ushort v12, v4, s[28:31], s35 offen offset:640
    buffer_load_ushort v13, v4, s[28:31], s35 offen offset:768
    buffer_load_ushort v14, v4, s[28:31], s35 offen offset:896
    s_waitcnt vmcnt(0)
    v_lshlrev_b32 v7, 16, v7
    v_mul_f32 v7, 0xbfb8aa3b, v7
    v_lshlrev_b32 v8, 16, v8
    v_mul_f32 v8, 0xbfb8aa3b, v8
    v_lshlrev_b32 v9, 16, v9
    v_mul_f32 v9, 0xbfb8aa3b, v9
    v_lshlrev_b32 v10, 16, v10
    v_mul_f32 v10, 0xbfb8aa3b, v10
    v_lshlrev_b32 v11, 16, v11
    v_mul_f32 v11, 0xbfb8aa3b, v11
    v_lshlrev_b32 v12, 16, v12
    v_mul_f32 v12, 0xbfb8aa3b, v12
    v_lshlrev_b32 v13, 16, v13
    v_mul_f32 v13, 0xbfb8aa3b, v13
    v_lshlrev_b32 v14, 16, v14
    v_mul_f32 v14, 0xbfb8aa3b, v14
    v_cvt_pk_bf16_f32 v16, v7, v8
    v_cvt_pk_bf16_f32 v17, v9, v10
    v_cvt_pk_bf16_f32 v18, v11, v12
    v_cvt_pk_bf16_f32 v19, v13, v14
    s_lshl_b32 s36, s33, 12
    s_lshl_b32 s37, s34, 10
    s_add_u32 s36, s36, s37
    s_add_u32 s36, s36, 0
    buffer_store_dwordx4 v[16:19], v5, s[24:27], s36 offen
    s_nop 1
    s_mov_b32 s28, s22
    s_mov_b32 s29, s23
    s_mov_b32 s30, 0x2000
    s_mov_b32 s31, 0x00020000
    buffer_load_ushort v7, v4, s[28:31], s35 offen offset:0
    buffer_load_ushort v8, v4, s[28:31], s35 offen offset:128
    buffer_load_ushort v9, v4, s[28:31], s35 offen offset:256
    buffer_load_ushort v10, v4, s[28:31], s35 offen offset:384
    buffer_load_ushort v11, v4, s[28:31], s35 offen offset:512
    buffer_load_ushort v12, v4, s[28:31], s35 offen offset:640
    buffer_load_ushort v13, v4, s[28:31], s35 offen offset:768
    buffer_load_ushort v14, v4, s[28:31], s35 offen offset:896
    s_waitcnt vmcnt(0)
    v_lshl_or_b32 v16, v8, 16, v7
    v_lshl_or_b32 v17, v10, 16, v9
    v_lshl_or_b32 v18, v12, 16, v11
    v_lshl_or_b32 v19, v14, 16, v13
    s_lshl_b32 s36, s33, 12
    s_lshl_b32 s37, s34, 10
    s_add_u32 s36, s36, s37
    s_add_u32 s36, s36, 8192
    buffer_store_dwordx4 v[16:19], v5, s[24:27], s36 offen
    s_nop 1
    s_mov_b32 s28, s12
    s_mov_b32 s29, s13
    s_mov_b32 s30, 0x2000
    s_mov_b32 s31, 0x00020000
    buffer_load_ushort v7, v4, s[28:31], s35 offen offset:0
    buffer_load_ushort v8, v4, s[28:31], s35 offen offset:128
    buffer_load_ushort v9, v4, s[28:31], s35 offen offset:256
    buffer_load_ushort v10, v4, s[28:31], s35 offen offset:384
    buffer_load_ushort v11, v4, s[28:31], s35 offen offset:512
    buffer_load_ushort v12, v4, s[28:31], s35 offen offset:640
    buffer_load_ushort v13, v4, s[28:31], s35 offen offset:768
    buffer_load_ushort v14, v4, s[28:31], s35 offen offset:896
    s_waitcnt vmcnt(0)
    v_lshl_or_b32 v16, v8, 16, v7
    v_lshl_or_b32 v17, v10, 16, v9
    v_lshl_or_b32 v18, v12, 16, v11
    v_lshl_or_b32 v19, v14, 16, v13
    s_lshl_b32 s36, s33, 12
    s_lshl_b32 s37, s34, 10
    s_add_u32 s36, s36, s37
    s_add_u32 s36, s36, 16384
    buffer_store_dwordx4 v[16:19], v5, s[24:27], s36 offen
    s_nop 1
    s_mov_b32 s28, s20
    s_mov_b32 s29, s21
    s_mov_b32 s30, 0x2000
    s_mov_b32 s31, 0x00020000
    buffer_load_ushort v7, v4, s[28:31], s35 offen offset:0
    buffer_load_ushort v8, v4, s[28:31], s35 offen offset:128
    buffer_load_ushort v9, v4, s[28:31], s35 offen offset:256
    buffer_load_ushort v10, v4, s[28:31], s35 offen offset:384
    buffer_load_ushort v11, v4, s[28:31], s35 offen offset:512
    buffer_load_ushort v12, v4, s[28:31], s35 offen offset:640
    buffer_load_ushort v13, v4, s[28:31], s35 offen offset:768
    buffer_load_ushort v14, v4, s[28:31], s35 offen offset:896
    s_waitcnt vmcnt(0)
    v_lshl_or_b32 v16, v8, 16, v7
    v_lshl_or_b32 v17, v10, 16, v9
    v_lshl_or_b32 v18, v12, 16, v11
    v_lshl_or_b32 v19, v14, 16, v13
    s_lshl_b32 s36, s33, 12
    s_lshl_b32 s37, s34, 10
    s_add_u32 s36, s36, s37
    s_add_u32 s36, s36, 24576
    buffer_store_dwordx4 v[16:19], v5, s[24:27], s36 offen
    s_nop 1
    s_cmp_gt_u32 s32, 1
    s_cbranch_scc1 L_part_end
    s_mov_b32 s28, s16
    s_mov_b32 s29, s17
    s_mov_b32 s30, 0x200
    s_mov_b32 s31, 0x00020000
    v_cmp_gt_u32 vcc, 32, v1
    s_and_saveexec_b64 s[40:41], vcc
    v_lshlrev_b32 v4, 2, v2
    s_lshl_b32 s35, s33, 1
    buffer_load_ushort v7, v4, s[28:31], s35 offen offset:0
    buffer_load_ushort v8, v4, s[28:31], s35 offen offset:128
    buffer_load_ushort v9, v4, s[28:31], s35 offen offset:256
    buffer_load_ushort v10, v4, s[28:31], s35 offen offset:384
    s_waitcnt vmcnt(0)
    v_lshlrev_b32 v7, 16, v7
    v_mul_f32 v7, 0xbfb8aa3b, v7
    v_lshlrev_b32 v8, 16, v8
    v_mul_f32 v8, 0xbfb8aa3b, v8
    v_lshlrev_b32 v9, 16, v9
    v_mul_f32 v9, 0xbfb8aa3b, v9
    v_lshlrev_b32 v10, 16, v10
    v_mul_f32 v10, 0xbfb8aa3b, v10
    v_cvt_pk_bf16_f32 v16, v7, v8
    v_cvt_pk_bf16_f32 v17, v9, v10
    v_lshlrev_b32 v5, 3, v2
    s_lshl_b32 s36, s33, 8
    s_add_u32 s36, s36, 32768
    buffer_store_dwordx2 v[16:17], v5, s[24:27], s36 offen
L_part_end:
    s_endpgm
.globl gs_main_kernel
.p2align 8
.type gs_main_kernel,@function
gs_main_kernel:
    s_cmp_ge_u32 s2, 250
    s_cbranch_scc1 L_main_end
    s_load_dwordx2 s[4:5], s[0:1], 0
    s_load_dwordx2 s[6:7], s[0:1], 88
    s_load_dwordx2 s[28:29], s[0:1], 72
    s_mov_b32 s53, s2
    s_waitcnt lgkmcnt(0)
    s_mov_b32 s8, s4
    s_mov_b32 s9, s5
    s_mov_b32 s10, 0x61a800
    s_mov_b32 s11, 0x00020000
    s_mov_b32 s12, s28
    s_mov_b32 s13, s29
    s_mov_b32 s14, 0x61a800
    s_mov_b32 s15, 0x00020000
    s_mov_b32 s16, s6
    s_mov_b32 s17, s7
    s_mov_b32 s18, 0x10000
    s_mov_b32 s19, 0x00020000
    s_add_u32 s20, s6, 0x10000
    s_addc_u32 s21, s7, 0
    s_mov_b32 s22, 0x1e8480
    s_mov_b32 s23, 0x00020000
    s_add_u32 s24, s6, 0x1f8480
    s_addc_u32 s25, s7, 0
    s_mov_b32 s26, 0x927c00
    s_mov_b32 s27, 0x00020000
    s_mov_b32 s44, -1
    s_mov_b32 s45, 0
    s_mov_b32 s46, 0
    s_mov_b32 s47, -1
    v_and_b32 v1, 63, v0
    v_lshrrev_b32 v13, 6, v0
    v_and_b32 v2, 31, v0
    v_readfirstlane_b32 s32, v13
    v_bfe_u32 v13, v0, 5, 1
    v_lshlrev_b32 v3, 4, v13
    v_lshlrev_b32 v8, 4, v1
    v_lshlrev_b32 v13, 5, v0
    v_cmp_gt_u32 vcc, 250, v0
    v_mov_b32 v14, 0x7fffff00
    s_mul_i32 s35, s53, 8000
    s_nop 1
    v_cndmask_b32_e64 v13, v14, v13, vcc
    buffer_load_dwordx4 v[224:227], v13, s[20:23], s35 offen
    buffer_load_dwordx4 v[228:231], v13, s[20:23], s35 offen offset:16
    v_lshlrev_b32 v13, 4, v0
    s_mov_b32 s36, 0
    buffer_load_dwordx4 v[200:203], v13, s[16:19], s36 offen
    s_add_u32 s36, s36, 8192
    buffer_load_dwordx4 v[204:207], v13, s[16:19], s36 offen
    s_add_u32 s36, s36, 8192
    buffer_load_dwordx4 v[208:211], v13, s[16:19], s36 offen
    s_add_u32 s36, s36, 8192
    buffer_load_dwordx4 v[212:215], v13, s[16:19], s36 offen
    v_lshlrev_b32 v4, 5, v3
    v_add_u32 v4, 32768, v4
    s_lshl_b32 s31, s32, 11
    s_add_u32 s31, s31, 124928
    v_lshlrev_b32 v6, 6, v2
    v_add_u32 v6, v6, v3
    v_add_u32 v6, s31, v6
    v_lshrrev_b32 v13, 4, v2
    v_lshlrev_b32 v5, 4, v13
    v_bfe_u32 v13, v2, 2, 1
    v_lshl_add_u32 v5, v13, 3, v5
    v_bfe_u32 v13, v2, 3, 1
    v_lshl_add_u32 v5, v13, 2, v5
    v_and_b32 v13, 3, v2
    v_add_u32 v5, v5, v13
    v_lshlrev_b32 v5, 1, v5
    v_add_u32 v5, s31, v5
    v_mov_b32 v9, v5
    v_mov_b32 v20, v5
    v_mov_b32 v10, 0x3f80
    v_mov_b32 v11, 0
    v_lshrrev_b32 v13, 8, v0
    v_bfe_u32 v14, v0, 7, 1
    v_lshlrev_b32 v15, 4, v13
    v_lshl_add_u32 v15, v14, 2, v15
    v_bfe_u32 v13, v0, 1, 1
    v_lshl_add_u32 v15, v13, 3, v15
    v_and_b32 v13, 1, v0
    v_lshl_add_u32 v15, v13, 1, v15
    v_bfe_u32 v14, v0, 2, 5
    v_sub_u32 v14, v14, v15
    v_cmp_eq_u32_e64 s[42:43], 0, v14
    v_cmp_eq_u32_e64 s[48:49], 1, v14
    v_mov_b32 v13, 0x3f80
    v_mov_b32 v15, 0x3f800000
    s_nop 1
    v_cndmask_b32_e64 v13, 0, v13, s[42:43]
    v_cndmask_b32_e64 v15, 0, v15, s[48:49]
    v_or_b32 v13, v13, v15
    v_lshlrev_b32 v14, 2, v0
    ds_write_b32 v14, v13 offset:32768
    v_mov_b32 v216, 0
    v_mov_b32 v217, 0
    v_mov_b32 v218, 0
    v_mov_b32 v219, 0
    v_lshlrev_b32 v13, 5, v1
    v_add_u32 v13, s31, v13
    ds_write_b128 v13, v[216:219]
    ds_write_b128 v13, v[216:219] offset:16
    s_waitcnt vmcnt(4)
    s_cmp_gt_u32 s32, 3
    s_cbranch_scc1 L_scan_done
    v_and_b32 v104, 0xffff, v224
    v_lshrrev_b32 v88, 16, v224
    v_mov_b32 v96, v88
    v_lshrrev_b32 v89, 16, v225
    v_mov_b32 v97, v89
    v_lshrrev_b32 v90, 16, v226
    v_mov_b32 v98, v90
    v_lshrrev_b32 v91, 16, v227
    v_mov_b32 v99, v91
    v_lshrrev_b32 v92, 16, v228
    v_mov_b32 v100, v92
    v_lshrrev_b32 v93, 16, v229
    v_mov_b32 v101, v93
    v_lshrrev_b32 v94, 16, v230
    v_mov_b32 v102, v94
    v_lshrrev_b32 v95, 16, v231
    v_mov_b32 v103, v95
    s_nop 1
    v_add_u32_dpp v96, v96, v96 row_shr:1 row_mask:0xf bank_mask:0xf bound_ctrl:0
    v_add_u32_dpp v97, v97, v97 row_shr:1 row_mask:0xf bank_mask:0xf bound_ctrl:0
    v_add_u32_dpp v98, v98, v98 row_shr:1 row_mask:0xf bank_mask:0xf bound_ctrl:0
    v_add_u32_dpp v99, v99, v99 row_shr:1 row_mask:0xf bank_mask:0xf bound_ctrl:0
    v_add_u32_dpp v100, v100, v100 row_shr:1 row_mask:0xf bank_mask:0xf bound_ctrl:0
    v_add_u32_dpp v101, v101, v101 row_shr:1 row_mask:0xf bank_mask:0xf bound_ctrl:0
    v_add_u32_dpp v102, v102, v102 row_shr:1 row_mask:0xf bank_mask:0xf bound_ctrl:0
    v_add_u32_dpp v103, v103, v103 row_shr:1 row_mask:0xf bank_mask:0xf bound_ctrl:0
    v_add_u32_dpp v96, v96, v96 row_shr:2 row_mask:0xf bank_mask:0xf bound_ctrl:0
    v_add_u32_dpp v97, v97, v97 row_shr:2 row_mask:0xf bank_mask:0xf bound_ctrl:0
    v_add_u32_dpp v98, v98, v98 row_shr:2 row_mask:0xf bank_mask:0xf bound_ctrl:0
    v_add_u32_dpp v99, v99, v99 row_shr:2 row_mask:0xf bank_mask:0xf bound_ctrl:0
    v_add_u32_dpp v100, v100, v100 row_shr:2 row_mask:0xf bank_mask:0xf bound_ctrl:0
    v_add_u32_dpp v101, v101, v101 row_shr:2 row_mask:0xf bank_mask:0xf bound_ctrl:0
    v_add_u32_dpp v102, v102, v102 row_shr:2 row_mask:0xf bank_mask:0xf bound_ctrl:0
    v_add_u32_dpp v103, v103, v103 row_shr:2 row_mask:0xf bank_mask:0xf bound_ctrl:0
    v_add_u32_dpp v96, v96, v96 row_shr:4 row_mask:0xf bank_mask:0xf bound_ctrl:0
    v_add_u32_dpp v97, v97, v97 row_shr:4 row_mask:0xf bank_mask:0xf bound_ctrl:0
    v_add_u32_dpp v98, v98, v98 row_shr:4 row_mask:0xf bank_mask:0xf bound_ctrl:0
    v_add_u32_dpp v99, v99, v99 row_shr:4 row_mask:0xf bank_mask:0xf bound_ctrl:0
    v_add_u32_dpp v100, v100, v100 row_shr:4 row_mask:0xf bank_mask:0xf bound_ctrl:0
    v_add_u32_dpp v101, v101, v101 row_shr:4 row_mask:0xf bank_mask:0xf bound_ctrl:0
    v_add_u32_dpp v102, v102, v102 row_shr:4 row_mask:0xf bank_mask:0xf bound_ctrl:0
    v_add_u32_dpp v103, v103, v103 row_shr:4 row_mask:0xf bank_mask:0xf bound_ctrl:0
    v_add_u32_dpp v96, v96, v96 row_shr:8 row_mask:0xf bank_mask:0xf bound_ctrl:0
    v_add_u32_dpp v97, v97, v97 row_shr:8 row_mask:0xf bank_mask:0xf bound_ctrl:0
    v_add_u32_dpp v98, v98, v98 row_shr:8 row_mask:0xf bank_mask:0xf bound_ctrl:0
    v_add_u32_dpp v99, v99, v99 row_shr:8 row_mask:0xf bank_mask:0xf bound_ctrl:0
    v_add_u32_dpp v100, v100, v100 row_shr:8 row_mask:0xf bank_mask:0xf bound_ctrl:0
    v_add_u32_dpp v101, v101, v101 row_shr:8 row_mask:0xf bank_mask:0xf bound_ctrl:0
    v_add_u32_dpp v102, v102, v102 row_shr:8 row_mask:0xf bank_mask:0xf bound_ctrl:0
    v_add_u32_dpp v103, v103, v103 row_shr:8 row_mask:0xf bank_mask:0xf bound_ctrl:0
    v_add_u32_dpp v96, v96, v96 row_bcast:15 row_mask:0xa bank_mask:0xf
    v_add_u32_dpp v97, v97, v97 row_bcast:15 row_mask:0xa bank_mask:0xf
    v_add_u32_dpp v98, v98, v98 row_bcast:15 row_mask:0xa bank_mask:0xf
    v_add_u32_dpp v99, v99, v99 row_bcast:15 row_mask:0xa bank_mask:0xf
    v_add_u32_dpp v100, v100, v100 row_bcast:15 row_mask:0xa bank_mask:0xf
    v_add_u32_dpp v101, v101, v101 row_bcast:15 row_mask:0xa bank_mask:0xf
    v_add_u32_dpp v102, v102, v102 row_bcast:15 row_mask:0xa bank_mask:0xf
    v_add_u32_dpp v103, v103, v103 row_bcast:15 row_mask:0xa bank_mask:0xf
    v_add_u32_dpp v96, v96, v96 row_bcast:31 row_mask:0xc bank_mask:0xf
    v_add_u32_dpp v97, v97, v97 row_bcast:31 row_mask:0xc bank_mask:0xf
    v_add_u32_dpp v98, v98, v98 row_bcast:31 row_mask:0xc bank_mask:0xf
    v_add_u32_dpp v99, v99, v99 row_bcast:31 row_mask:0xc bank_mask:0xf
    v_add_u32_dpp v100, v100, v100 row_bcast:31 row_mask:0xc bank_mask:0xf
    v_add_u32_dpp v101, v101, v101 row_bcast:31 row_mask:0xc bank_mask:0xf
    v_add_u32_dpp v102, v102, v102 row_bcast:31 row_mask:0xc bank_mask:0xf
    v_add_u32_dpp v103, v103, v103 row_bcast:31 row_mask:0xc bank_mask:0xf
    s_nop 1
    s_lshl_b32 s35, s32, 6
    v_mov_b32 v13, s35
    s_mov_b32 exec_lo, 0
    s_mov_b32 exec_hi, 0x80000000
    ds_write_b128 v13, v[96:99] offset:47104
    ds_write_b128 v13, v[100:103] offset:47120
    s_mov_b64 exec, -1
L_scan_done:
    s_waitcnt lgkmcnt(0)
    s_barrier
    v_and_b32 v13, 7, v1
    v_lshlrev_b32 v13, 2, v13
    ds_read_b32 v24, v13 offset:47104
    ds_read_b32 v25, v13 offset:47168
    ds_read_b32 v26, v13 offset:47232
    ds_read_b32 v27, v13 offset:47296
    s_waitcnt lgkmcnt(0)
    v_mov_b32 v28, 0
    s_cmp_gt_u32 s32, 0
    s_cselect_b32 s35, -1, 0
    v_and_b32 v14, s35, v24
    v_add_u32 v28, v28, v14
    s_cmp_gt_u32 s32, 1
    s_cselect_b32 s35, -1, 0
    v_and_b32 v14, s35, v25
    v_add_u32 v28, v28, v14
    s_cmp_gt_u32 s32, 2
    s_cselect_b32 s35, -1, 0
    v_and_b32 v14, s35, v26
    v_add_u32 v28, v28, v14
    v_add3_u32 v244, v24, v25, v26
    v_add_u32 v244, v244, v27
    s_nop 1
    v_readlane_b32 s54, v28, 0
    v_readlane_b32 s62, v244, 0
    v_readlane_b32 s55, v28, 1
    v_readlane_b32 s63, v244, 1
    v_readlane_b32 s56, v28, 2
    v_readlane_b32 s64, v244, 2
    v_readlane_b32 s57, v28, 3
    v_readlane_b32 s65, v244, 3
    v_readlane_b32 s58, v28, 4
    v_readlane_b32 s66, v244, 4
    v_readlane_b32 s59, v28, 5
    v_readlane_b32 s67, v244, 5
    v_readlane_b32 s60, v28, 6
    v_readlane_b32 s68, v244, 6
    v_readlane_b32 s61, v28, 7
    v_readlane_b32 s69, v244, 7
    s_nop 3
    s_max_u32 s35, s62, s63
    s_max_u32 s35, s35, s64
    s_max_u32 s35, s35, s65
    s_max_u32 s35, s35, s66
    s_max_u32 s35, s35, s67
    s_max_u32 s35, s35, s68
    s_max_u32 s35, s35, s69
    s_cmp_gt_u32 s35, 512
    s_cbranch_scc0 L_fast_1
    s_mov_b32 s51, s32
    s_lshl_b32 s33, s53, 3
    s_add_u32 s33, s33, s51
    s_mul_i32 s35, s33, 3200
    v_lshl_add_u32 v13, v2, 7, v3
    v_cmp_gt_u32_e64 s[42:43], 25, v2
    v_mov_b32 v15, 0x7fffff00
    s_nop 0
    v_cndmask_b32_e64 v13, v15, v13, s[42:43]
    buffer_load_dwordx4 v[168:171], v13, s[8:11], s35 offen offset:0
    buffer_load_dwordx4 v[172:175], v13, s[8:11], s35 offen offset:32
    buffer_load_dwordx4 v[176:179], v13, s[8:11], s35 offen offset:64
    buffer_load_dwordx4 v[180:183], v13, s[8:11], s35 offen offset:96
    v_lshlrev_b32 v13, 3, v2
    s_mov_b32 s36, 32768
    buffer_load_dword v232, v13, s[16:19], s36 offen
    buffer_load_dword v233, v13, s[16:19], s36 offen offset:4
    s_mov_b32 s36, 33024
    buffer_load_dword v234, v13, s[16:19], s36 offen
    buffer_load_dword v235, v13, s[16:19], s36 offen offset:4
    s_branch L_slow
L_fast_1:
    s_cmp_gt_u32 s32, 3
    s_cbranch_scc1 L_f2_done
    v_mov_b32 v108, 0
    v_add_u32 v109, v108, v88
    v_add_u32 v110, v109, v89
    v_add_u32 v111, v110, v90
    v_add_u32 v112, v111, v91
    v_add_u32 v113, v112, v92
    v_add_u32 v114, v113, v93
    v_add_u32 v115, v114, v94
    v_add_u32 v116, v115, v95
    v_sub_u32 v96, v96, v88
    v_add_u32 v96, s54, v96
    v_sub_u32 v96, v96, v108
    v_lshlrev_b32 v96, 4, v96
    v_add_u32 v56, 0xc800, v96
    v_sub_u32 v97, v97, v89
    v_add_u32 v97, s55, v97
    v_sub_u32 v97, v97, v109
    v_lshlrev_b32 v97, 4, v97
    v_add_u32 v57, 0xec00, v97
    v_sub_u32 v98, v98, v90
    v_add_u32 v98, s56, v98
    v_sub_u32 v98, v98, v110
    v_lshlrev_b32 v98, 4, v98
    v_add_u32 v58, 0x11000, v98
    v_sub_u32 v99, v99, v91
    v_add_u32 v99, s57, v99
    v_sub_u32 v99, v99, v111
    v_lshlrev_b32 v99, 4, v99
    v_add_u32 v59, 0x13400, v99
    v_sub_u32 v100, v100, v92
    v_add_u32 v100, s58, v100
    v_sub_u32 v100, v100, v112
    v_lshlrev_b32 v100, 4, v100
    v_add_u32 v60, 0x15800, v100
    v_sub_u32 v101, v101, v93
    v_add_u32 v101, s59, v101
    v_sub_u32 v101, v101, v113
    v_lshlrev_b32 v101, 4, v101
    v_add_u32 v61, 0x17c00, v101
    v_sub_u32 v102, v102, v94
    v_add_u32 v102, s60, v102
    v_sub_u32 v102, v102, v114
    v_lshlrev_b32 v102, 4, v102
    v_add_u32 v62, 0x1a000, v102
    v_sub_u32 v103, v103, v95
    v_add_u32 v103, s61, v103
    v_sub_u32 v103, v103, v115
    v_lshlrev_b32 v103, 4, v103
    v_add_u32 v63, 0x1c400, v103
    v_mul_u32_u24 v106, 3200, v0
    v_add_u32 v106, v106, v104
    v_mov_b32 v107, v116
    v_lshlrev_b32 v13, 5, v0
    ds_write_b128 v13, v[56:59] offset:34816
    ds_write_b128 v13, v[60:63] offset:34832
    v_lshlrev_b32 v13, 3, v0
    ds_write_b64 v13, v[106:107] offset:43008
L_f2_done:
    s_waitcnt vmcnt(0)
    v_lshlrev_b32 v13, 4, v0
    ds_write_b128 v13, v[200:203] offset:0
    ds_write_b128 v13, v[204:207] offset:8192
    ds_write_b128 v13, v[208:211] offset:16384
    ds_write_b128 v13, v[212:215] offset:24576
    s_waitcnt lgkmcnt(0)
    s_barrier
    v_bfe_u32 v13, v0, 5, 4
    v_lshlrev_b32 v21, 3, v13
    v_lshlrev_b32 v18, 5, v13
    v_add_u32 v18, 34816, v18
    ds_read_b64 v[184:185], v21 offset:43008
    ds_read_b64 v[186:187], v21 offset:43136
    ds_read_b64 v[188:189], v21 offset:43264
    ds_read_b64 v[190:191], v21 offset:43392
    ds_read_b64 v[192:193], v21 offset:43520
    ds_read_b64 v[194:195], v21 offset:43648
    ds_read_b64 v[196:197], v21 offset:43776
    ds_read_b64 v[198:199], v21 offset:43904
    ds_read_b64 v[200:201], v21 offset:44032
    ds_read_b64 v[202:203], v21 offset:44160
    ds_read_b64 v[204:205], v21 offset:44288
    ds_read_b64 v[206:207], v21 offset:44416
    ds_read_b64 v[208:209], v21 offset:44544
    ds_read_b64 v[210:211], v21 offset:44672
    ds_read_b64 v[212:213], v21 offset:44800
    ds_read_b64 v[214:215], v21 offset:44928
    v_mov_b32 v16, v2
    s_mov_b32 s41, 0
    s_waitcnt lgkmcnt(0)
    v_mov_b32 v12, v185
    v_max_u32 v12, v12, v187
    v_max_u32 v12, v12, v189
    v_max_u32 v12, v12, v191
    v_max_u32 v12, v12, v193
    v_max_u32 v12, v12, v195
    v_max_u32 v12, v12, v197
    v_max_u32 v12, v12, v199
    v_max_u32 v12, v12, v201
    v_max_u32 v12, v12, v203
    v_max_u32 v12, v12, v205
    v_max_u32 v12, v12, v207
    v_max_u32 v12, v12, v209
    v_max_u32 v12, v12, v211
    v_max_u32 v12, v12, v213
    v_max_u32 v12, v12, v215
L_f3:
    s_waitcnt lgkmcnt(0)
    v_cmp_lt_u32_e64 s[64:65], v16, v185
    v_cmp_lt_u32_e64 s[66:67], v16, v187
    v_cmp_lt_u32_e64 s[68:69], v16, v189
    v_cmp_lt_u32_e64 s[70:71], v16, v191
    v_cmp_lt_u32_e64 s[72:73], v16, v193
    v_cmp_lt_u32_e64 s[74:75], v16, v195
    v_cmp_lt_u32_e64 s[76:77], v16, v197
    v_cmp_lt_u32_e64 s[78:79], v16, v199
    v_cmp_lt_u32_e64 s[80:81], v16, v201
    v_cmp_lt_u32_e64 s[82:83], v16, v203
    v_cmp_lt_u32_e64 s[84:85], v16, v205
    v_cmp_lt_u32_e64 s[86:87], v16, v207
    v_cmp_lt_u32_e64 s[88:89], v16, v209
    v_cmp_lt_u32_e64 s[90:91], v16, v211
    v_cmp_lt_u32_e64 s[92:93], v16, v213
    v_cmp_lt_u32_e64 s[94:95], v16, v215
    v_mov_b32 v15, 0x7fffff00
    v_add_u32 v13, v184, v16
    v_lshlrev_b32 v14, 2, v13
    v_lshl_add_u32 v13, v13, 3, v14
    v_cndmask_b32_e64 v13, v15, v13, s[64:65]
    buffer_load_dwordx3 v[24:26], v13, s[24:27], 0 offen
    v_add_u32 v13, v186, v16
    v_lshlrev_b32 v14, 2, v13
    v_lshl_add_u32 v13, v13, 3, v14
    v_cndmask_b32_e64 v13, v15, v13, s[66:67]
    buffer_load_dwordx3 v[28:30], v13, s[24:27], 0 offen
    v_add_u32 v13, v188, v16
    v_lshlrev_b32 v14, 2, v13
    v_lshl_add_u32 v13, v13, 3, v14
    v_cndmask_b32_e64 v13, v15, v13, s[68:69]
    buffer_load_dwordx3 v[32:34], v13, s[24:27], 0 offen
    v_add_u32 v13, v190, v16
    v_lshlrev_b32 v14, 2, v13
    v_lshl_add_u32 v13, v13, 3, v14
    v_cndmask_b32_e64 v13, v15, v13, s[70:71]
    buffer_load_dwordx3 v[36:38], v13, s[24:27], 0 offen
    v_add_u32 v13, v192, v16
    v_lshlrev_b32 v14, 2, v13
    v_lshl_add_u32 v13, v13, 3, v14
    v_cndmask_b32_e64 v13, v15, v13, s[72:73]
    buffer_load_dwordx3 v[40:42], v13, s[24:27], 0 offen
    v_add_u32 v13, v194, v16
    v_lshlrev_b32 v14, 2, v13
    v_lshl_add_u32 v13, v13, 3, v14
    v_cndmask_b32_e64 v13, v15, v13, s[74:75]
    buffer_load_dwordx3 v[44:46], v13, s[24:27], 0 offen
    v_add_u32 v13, v196, v16
    v_lshlrev_b32 v14, 2, v13
    v_lshl_add_u32 v13, v13, 3, v14
    v_cndmask_b32_e64 v13, v15, v13, s[76:77]
    buffer_load_dwordx3 v[48:50], v13, s[24:27], 0 offen
    v_add_u32 v13, v198, v16
    v_lshlrev_b32 v14, 2, v13
    v_lshl_add_u32 v13, v13, 3, v14
    v_cndmask_b32_e64 v13, v15, v13, s[78:79]
    buffer_load_dwordx3 v[52:54], v13, s[24:27], 0 offen
    v_add_u32 v13, v200, v16
    v_lshlrev_b32 v14, 2, v13
    v_lshl_add_u32 v13, v13, 3, v14
    v_cndmask_b32_e64 v13, v15, v13, s[80:81]
    buffer_load_dwordx3 v[56:58], v13, s[24:27], 0 offen
    v_add_u32 v13, v202, v16
    v_lshlrev_b32 v14, 2, v13
    v_lshl_add_u32 v13, v13, 3, v14
    v_cndmask_b32_e64 v13, v15, v13, s[82:83]
    buffer_load_dwordx3 v[60:62], v13, s[24:27], 0 offen
    v_add_u32 v13, v204, v16
    v_lshlrev_b32 v14, 2, v13
    v_lshl_add_u32 v13, v13, 3, v14
    v_cndmask_b32_e64 v13, v15, v13, s[84:85]
    buffer_load_dwordx3 v[64:66], v13, s[24:27], 0 offen
    v_add_u32 v13, v206, v16
    v_lshlrev_b32 v14, 2, v13
    v_lshl_add_u32 v13, v13, 3, v14
    v_cndmask_b32_e64 v13, v15, v13, s[86:87]
    buffer_load_dwordx3 v[68:70], v13, s[24:27], 0 offen
    v_add_u32 v13, v208, v16
    v_lshlrev_b32 v14, 2, v13
    v_lshl_add_u32 v13, v13, 3, v14
    v_cndmask_b32_e64 v13, v15, v13, s[88:89]
    buffer_load_dwordx3 v[72:74], v13, s[24:27], 0 offen
    v_add_u32 v13, v210, v16
    v_lshlrev_b32 v14, 2, v13
    v_lshl_add_u32 v13, v13, 3, v14
    v_cndmask_b32_e64 v13, v15, v13, s[90:91]
    buffer_load_dwordx3 v[76:78], v13, s[24:27], 0 offen
    v_add_u32 v13, v212, v16
    v_lshlrev_b32 v14, 2, v13
    v_lshl_add_u32 v13, v13, 3, v14
    v_cndmask_b32_e64 v13, v15, v13, s[92:93]
    buffer_load_dwordx3 v[80:82], v13, s[24:27], 0 offen
    v_add_u32 v13, v214, v16
    v_lshlrev_b32 v14, 2, v13
    v_lshl_add_u32 v13, v13, 3, v14
    v_cndmask_b32_e64 v13, v15, v13, s[94:95]
    buffer_load_dwordx3 v[84:86], v13, s[24:27], 0 offen
    s_cmp_lg_u32 s41, 0
    s_cbranch_scc1 L_f3_later_2
    s_mov_b32 s51, s32
    v_and_b32 v13, 7, v1
    v_sub_u32 v13, 7, v13
    v_lshl_or_b32 v13, v244, 3, v13
    v_mov_b32 v14, 0
    v_readlane_b32 s35, v244, 0
    s_lshl_b32 s35, s35, 3
    s_or_b32 s35, s35, 7
    v_cmp_gt_u32_e64 s[42:43], s35, v13
    v_addc_co_u32_e64 v14, s[48:49], 0, v14, s[42:43]
    v_readlane_b32 s35, v244, 1
    s_lshl_b32 s35, s35, 3
    s_or_b32 s35, s35, 6
    v_cmp_gt_u32_e64 s[42:43], s35, v13
    v_addc_co_u32_e64 v14, s[48:49], 0, v14, s[42:43]
    v_readlane_b32 s35, v244, 2
    s_lshl_b32 s35, s35, 3
    s_or_b32 s35, s35, 5
    v_cmp_gt_u32_e64 s[42:43], s35, v13
    v_addc_co_u32_e64 v14, s[48:49], 0, v14, s[42:43]
    v_readlane_b32 s35, v244, 3
    s_lshl_b32 s35, s35, 3
    s_or_b32 s35, s35, 4
    v_cmp_gt_u32_e64 s[42:43], s35, v13
    v_addc_co_u32_e64 v14, s[48:49], 0, v14, s[42:43]
    v_readlane_b32 s35, v244, 4
    s_lshl_b32 s35, s35, 3
    s_or_b32 s35, s35, 3
    v_cmp_gt_u32_e64 s[42:43], s35, v13
    v_addc_co_u32_e64 v14, s[48:49], 0, v14, s[42:43]
    v_readlane_b32 s35, v244, 5
    s_lshl_b32 s35, s35, 3
    s_or_b32 s35, s35, 2
    v_cmp_gt_u32_e64 s[42:43], s35, v13
    v_addc_co_u32_e64 v14, s[48:49], 0, v14, s[42:43]
    v_readlane_b32 s35, v244, 6
    s_lshl_b32 s35, s35, 3
    s_or_b32 s35, s35, 1
    v_cmp_gt_u32_e64 s[42:43], s35, v13
    v_addc_co_u32_e64 v14, s[48:49], 0, v14, s[42:43]
    v_readlane_b32 s35, v244, 7
    s_lshl_b32 s35, s35, 3
    s_or_b32 s35, s35, 0
    v_cmp_gt_u32_e64 s[42:43], s35, v13
    v_addc_co_u32_e64 v14, s[48:49], 0, v14, s[42:43]
    s_sub_u32 s35, 11, s32
    s_cmp_gt_u32 s32, 3
    s_cselect_b32 s35, s35, s32
    v_cmp_eq_u32_e64 s[42:43], s35, v14
    s_ff1_i32_b64 s51, s[42:43]
    s_lshl_b32 s33, s53, 3
    s_add_u32 s33, s33, s51
    s_mul_i32 s35, s33, 3200
    v_lshl_add_u32 v13, v2, 7, v3
    v_cmp_gt_u32_e64 s[42:43], 25, v2
    v_mov_b32 v15, 0x7fffff00
    s_nop 0
    v_cndmask_b32_e64 v13, v15, v13, s[42:43]
    buffer_load_dwordx4 v[168:171], v13, s[8:11], s35 offen offset:0
    buffer_load_dwordx4 v[172:175], v13, s[8:11], s35 offen offset:32
    buffer_load_dwordx4 v[176:179], v13, s[8:11], s35 offen offset:64
    buffer_load_dwordx4 v[180:183], v13, s[8:11], s35 offen offset:96
    v_lshlrev_b32 v13, 3, v2
    s_mov_b32 s36, 32768
    buffer_load_dword v232, v13, s[16:19], s36 offen
    buffer_load_dword v233, v13, s[16:19], s36 offen offset:4
    s_mov_b32 s36, 33024
    buffer_load_dword v234, v13, s[16:19], s36 offen
    buffer_load_dword v235, v13, s[16:19], s36 offen offset:4
    v_readlane_b32 s39, v244, s51
    s_mul_i32 s30, s51, 9216
    s_add_u32 s30, s30, 51200
    v_lshlrev_b32 v7, 4, v2
    v_add_u32 v7, s30, v7
    s_add_u32 s40, s39, 31
    s_lshr_b32 s40, s40, 5
    v_mov_b32 v152, 0
    v_mov_b32 v153, 0
    v_mov_b32 v154, 0x7fffff00
    v_mov_b32 v155, 496
    s_lshl_b32 s35, s40, 5
    s_add_u32 s35, s35, 64
    v_add_u32 v13, s39, v1
    v_lshlrev_b32 v14, 4, v13
    v_add_u32 v14, s30, v14
    v_cmp_gt_u32_e64 s[42:43], s35, v13
    s_mov_b64 exec, s[42:43]
    ds_write_b128 v14, v[152:155] offset:0
    s_mov_b64 exec, -1
    v_add_u32 v13, 64, v13
    v_cmp_gt_u32_e64 s[42:43], s35, v13
    s_mov_b64 exec, s[42:43]
    ds_write_b128 v14, v[152:155] offset:1024
    s_mov_b64 exec, -1
    s_waitcnt vmcnt(8) lgkmcnt(0)
    s_branch L_f3_join_3
L_f3_later_2:
    s_waitcnt vmcnt(0) lgkmcnt(0)
L_f3_join_3:
    v_bfe_u32 v13, v26, 21, 3
    v_lshl_add_u32 v13, v13, 2, v18
    ds_read_b32 v216, v13 offset:0
    v_bfe_u32 v13, v30, 21, 3
    v_lshl_add_u32 v13, v13, 2, v18
    ds_read_b32 v217, v13 offset:512
    v_bfe_u32 v13, v34, 21, 3
    v_lshl_add_u32 v13, v13, 2, v18
    ds_read_b32 v218, v13 offset:1024
    v_bfe_u32 v13, v38, 21, 3
    v_lshl_add_u32 v13, v13, 2, v18
    ds_read_b32 v219, v13 offset:1536
    v_bfe_u32 v13, v42, 21, 3
    v_lshl_add_u32 v13, v13, 2, v18
    ds_read_b32 v220, v13 offset:2048
    v_bfe_u32 v13, v46, 21, 3
    v_lshl_add_u32 v13, v13, 2, v18
    ds_read_b32 v221, v13 offset:2560
    v_bfe_u32 v13, v50, 21, 3
    v_lshl_add_u32 v13, v13, 2, v18
    ds_read_b32 v222, v13 offset:3072
    v_bfe_u32 v13, v54, 21, 3
    v_lshl_add_u32 v13, v13, 2, v18
    ds_read_b32 v223, v13 offset:3584
    v_bfe_u32 v13, v58, 21, 3
    v_lshl_add_u32 v13, v13, 2, v18
    ds_read_b32 v224, v13 offset:4096
    v_bfe_u32 v13, v62, 21, 3
    v_lshl_add_u32 v13, v13, 2, v18
    ds_read_b32 v225, v13 offset:4608
    v_bfe_u32 v13, v66, 21, 3
    v_lshl_add_u32 v13, v13, 2, v18
    ds_read_b32 v226, v13 offset:5120
    v_bfe_u32 v13, v70, 21, 3
    v_lshl_add_u32 v13, v13, 2, v18
    ds_read_b32 v227, v13 offset:5632
    v_bfe_u32 v13, v74, 21, 3
    v_lshl_add_u32 v13, v13, 2, v18
    ds_read_b32 v228, v13 offset:6144
    v_bfe_u32 v13, v78, 21, 3
    v_lshl_add_u32 v13, v13, 2, v18
    ds_read_b32 v229, v13 offset:6656
    v_bfe_u32 v13, v82, 21, 3
    v_lshl_add_u32 v13, v13, 2, v18
    ds_read_b32 v230, v13 offset:7168
    v_bfe_u32 v13, v86, 21, 3
    v_lshl_add_u32 v13, v13, 2, v18
    ds_read_b32 v231, v13 offset:7680
    v_lshlrev_b32 v15, 4, v1
    v_add_u32 v15, 49152, v15
    v_lshrrev_b32 v27, 12, v26
    v_and_b32 v27, 0x1f0, v27
    v_and_b32 v26, 0xffff, v26
    v_lshlrev_b32 v26, 7, v26
    v_lshrrev_b32 v31, 12, v30
    v_and_b32 v31, 0x1f0, v31
    v_and_b32 v30, 0xffff, v30
    v_lshlrev_b32 v30, 7, v30
    v_lshrrev_b32 v35, 12, v34
    v_and_b32 v35, 0x1f0, v35
    v_and_b32 v34, 0xffff, v34
    v_lshlrev_b32 v34, 7, v34
    v_lshrrev_b32 v39, 12, v38
    v_and_b32 v39, 0x1f0, v39
    v_and_b32 v38, 0xffff, v38
    v_lshlrev_b32 v38, 7, v38
    v_lshrrev_b32 v43, 12, v42
    v_and_b32 v43, 0x1f0, v43
    v_and_b32 v42, 0xffff, v42
    v_lshlrev_b32 v42, 7, v42
    v_lshrrev_b32 v47, 12, v46
    v_and_b32 v47, 0x1f0, v47
    v_and_b32 v46, 0xffff, v46
    v_lshlrev_b32 v46, 7, v46
    v_lshrrev_b32 v51, 12, v50
    v_and_b32 v51, 0x1f0, v51
    v_and_b32 v50, 0xffff, v50
    v_lshlrev_b32 v50, 7, v50
    v_lshrrev_b32 v55, 12, v54
    v_and_b32 v55, 0x1f0, v55
    v_and_b32 v54, 0xffff, v54
    v_lshlrev_b32 v54, 7, v54
    v_lshrrev_b32 v59, 12, v58
    v_and_b32 v59, 0x1f0, v59
    v_and_b32 v58, 0xffff, v58
    v_lshlrev_b32 v58, 7, v58
    v_lshrrev_b32 v63, 12, v62
    v_and_b32 v63, 0x1f0, v63
    v_and_b32 v62, 0xffff, v62
    v_lshlrev_b32 v62, 7, v62
    v_lshrrev_b32 v67, 12, v66
    v_and_b32 v67, 0x1f0, v67
    v_and_b32 v66, 0xffff, v66
    v_lshlrev_b32 v66, 7, v66
    v_lshrrev_b32 v71, 12, v70
    v_and_b32 v71, 0x1f0, v71
    v_and_b32 v70, 0xffff, v70
    v_lshlrev_b32 v70, 7, v70
    v_lshrrev_b32 v75, 12, v74
    v_and_b32 v75, 0x1f0, v75
    v_and_b32 v74, 0xffff, v74
    v_lshlrev_b32 v74, 7, v74
    v_lshrrev_b32 v79, 12, v78
    v_and_b32 v79, 0x1f0, v79
    v_and_b32 v78, 0xffff, v78
    v_lshlrev_b32 v78, 7, v78
    v_lshrrev_b32 v83, 12, v82
    v_and_b32 v83, 0x1f0, v83
    v_and_b32 v82, 0xffff, v82
    v_lshlrev_b32 v82, 7, v82
    v_lshrrev_b32 v87, 12, v86
    v_and_b32 v87, 0x1f0, v87
    v_and_b32 v86, 0xffff, v86
    v_lshlrev_b32 v86, 7, v86
    s_waitcnt lgkmcnt(0)
    v_lshl_add_u32 v216, v16, 4, v216
    v_cndmask_b32_e64 v216, v15, v216, s[64:65]
    ds_write_b128 v216, v[24:27]
    v_lshl_add_u32 v217, v16, 4, v217
    v_cndmask_b32_e64 v217, v15, v217, s[66:67]
    ds_write_b128 v217, v[28:31]
    v_lshl_add_u32 v218, v16, 4, v218
    v_cndmask_b32_e64 v218, v15, v218, s[68:69]
    ds_write_b128 v218, v[32:35]
    v_lshl_add_u32 v219, v16, 4, v219
    v_cndmask_b32_e64 v219, v15, v219, s[70:71]
    ds_write_b128 v219, v[36:39]
    v_lshl_add_u32 v220, v16, 4, v220
    v_cndmask_b32_e64 v220, v15, v220, s[72:73]
    ds_write_b128 v220, v[40:43]
    v_lshl_add_u32 v221, v16, 4, v221
    v_cndmask_b32_e64 v221, v15, v221, s[74:75]
    ds_write_b128 v221, v[44:47]
    v_lshl_add_u32 v222, v16, 4, v222
    v_cndmask_b32_e64 v222, v15, v222, s[76:77]
    ds_write_b128 v222, v[48:51]
    v_lshl_add_u32 v223, v16, 4, v223
    v_cndmask_b32_e64 v223, v15, v223, s[78:79]
    ds_write_b128 v223, v[52:55]
    v_lshl_add_u32 v224, v16, 4, v224
    v_cndmask_b32_e64 v224, v15, v224, s[80:81]
    ds_write_b128 v224, v[56:59]
    v_lshl_add_u32 v225, v16, 4, v225
    v_cndmask_b32_e64 v225, v15, v225, s[82:83]
    ds_write_b128 v225, v[60:63]
    v_lshl_add_u32 v226, v16, 4, v226
    v_cndmask_b32_e64 v226, v15, v226, s[84:85]
    ds_write_b128 v226, v[64:67]
    v_lshl_add_u32 v227, v16, 4, v227
    v_cndmask_b32_e64 v227, v15, v227, s[86:87]
    ds_write_b128 v227, v[68:71]
    v_lshl_add_u32 v228, v16, 4, v228
    v_cndmask_b32_e64 v228, v15, v228, s[88:89]
    ds_write_b128 v228, v[72:75]
    v_lshl_add_u32 v229, v16, 4, v229
    v_cndmask_b32_e64 v229, v15, v229, s[90:91]
    ds_write_b128 v229, v[76:79]
    v_lshl_add_u32 v230, v16, 4, v230
    v_cndmask_b32_e64 v230, v15, v230, s[92:93]
    ds_write_b128 v230, v[80:83]
    v_lshl_add_u32 v231, v16, 4, v231
    v_cndmask_b32_e64 v231, v15, v231, s[94:95]
    ds_write_b128 v231, v[84:87]
    v_add_u32 v16, 32, v16
    s_add_u32 s41, s41, 1
    v_cmp_lt_u32 vcc, v16, v12
    s_cbranch_vccnz L_f3
    s_waitcnt vmcnt(0) lgkmcnt(0)
    ds_read_b128 v[216:219], v8 offset:16384
    ds_read_b128 v[220:223], v8 offset:17408
    ds_read_b128 v[224:227], v8 offset:18432
    ds_read_b128 v[228:231], v8 offset:19456
    s_waitcnt lgkmcnt(0)
    v_mfma_f32_32x32x16_bf16 v[88:103], v[168:171], v[216:219], 0
    v_mfma_f32_32x32x16_bf16 v[88:103], v[172:175], v[220:223], v[88:103]
    v_mfma_f32_32x32x16_bf16 v[88:103], v[176:179], v[224:227], v[88:103]
    v_mfma_f32_32x32x16_bf16 v[88:103], v[180:183], v[228:231], v[88:103]
    ds_read_b128 v[216:219], v8 offset:20480
    ds_read_b128 v[220:223], v8 offset:21504
    ds_read_b128 v[224:227], v8 offset:22528
    ds_read_b128 v[228:231], v8 offset:23552
    s_waitcnt lgkmcnt(0)
    v_mfma_f32_32x32x16_bf16 v[104:119], v[168:171], v[216:219], 0
    v_mfma_f32_32x32x16_bf16 v[104:119], v[172:175], v[220:223], v[104:119]
    v_mfma_f32_32x32x16_bf16 v[104:119], v[176:179], v[224:227], v[104:119]
    v_mfma_f32_32x32x16_bf16 v[104:119], v[180:183], v[228:231], v[104:119]
    ds_read_b128 v[216:219], v8 offset:24576
    ds_read_b128 v[220:223], v8 offset:25600
    ds_read_b128 v[224:227], v8 offset:26624
    ds_read_b128 v[228:231], v8 offset:27648
    s_waitcnt lgkmcnt(0)
    v_mfma_f32_32x32x16_bf16 v[120:135], v[168:171], v[216:219], 0
    v_mfma_f32_32x32x16_bf16 v[120:135], v[172:175], v[220:223], v[120:135]
    v_mfma_f32_32x32x16_bf16 v[120:135], v[176:179], v[224:227], v[120:135]
    v_mfma_f32_32x32x16_bf16 v[120:135], v[180:183], v[228:231], v[120:135]
    ds_read_b128 v[216:219], v8 offset:28672
    ds_read_b128 v[220:223], v8 offset:29696
    ds_read_b128 v[224:227], v8 offset:30720
    ds_read_b128 v[228:231], v8 offset:31744
    s_waitcnt lgkmcnt(0)
    v_mfma_f32_32x32x16_bf16 v[136:151], v[168:171], v[216:219], 0
    v_mfma_f32_32x32x16_bf16 v[136:151], v[172:175], v[220:223], v[136:151]
    v_mfma_f32_32x32x16_bf16 v[136:151], v[176:179], v[224:227], v[136:151]
    v_mfma_f32_32x32x16_bf16 v[136:151], v[180:183], v[228:231], v[136:151]
    s_nop 7
    s_nop 7
    v_mul_f32 v88, 0xbfb8aa3b, v88
    v_mul_f32 v89, 0xbfb8aa3b, v89
    v_mul_f32 v90, 0xbfb8aa3b, v90
    v_mul_f32 v91, 0xbfb8aa3b, v91
    v_mul_f32 v92, 0xbfb8aa3b, v92
    v_mul_f32 v93, 0xbfb8aa3b, v93
    v_mul_f32 v94, 0xbfb8aa3b, v94
    v_mul_f32 v95, 0xbfb8aa3b, v95
    v_mul_f32 v96, 0xbfb8aa3b, v96
    v_mul_f32 v97, 0xbfb8aa3b, v97
    v_mul_f32 v98, 0xbfb8aa3b, v98
    v_mul_f32 v99, 0xbfb8aa3b, v99
    v_mul_f32 v100, 0xbfb8aa3b, v100
    v_mul_f32 v101, 0xbfb8aa3b, v101
    v_mul_f32 v102, 0xbfb8aa3b, v102
    v_mul_f32 v103, 0xbfb8aa3b, v103
    v_mul_f32 v104, 0xbfb8aa3b, v104
    v_mul_f32 v105, 0xbfb8aa3b, v105
    v_mul_f32 v106, 0xbfb8aa3b, v106
    v_mul_f32 v107, 0xbfb8aa3b, v107
    v_mul_f32 v108, 0xbfb8aa3b, v108
    v_mul_f32 v109, 0xbfb8aa3b, v109
    v_mul_f32 v110, 0xbfb8aa3b, v110
    v_mul_f32 v111, 0xbfb8aa3b, v111
    v_mul_f32 v112, 0xbfb8aa3b, v112
    v_mul_f32 v113, 0xbfb8aa3b, v113
    v_mul_f32 v114, 0xbfb8aa3b, v114
    v_mul_f32 v115, 0xbfb8aa3b, v115
    v_mul_f32 v116, 0xbfb8aa3b, v116
    v_mul_f32 v117, 0xbfb8aa3b, v117
    v_mul_f32 v118, 0xbfb8aa3b, v118
    v_mul_f32 v119, 0xbfb8aa3b, v119
    v_cvt_pk_bf16_f32 v152, v88, v89
    v_cvt_pk_bf16_f32 v153, v90, v91
    v_cvt_pk_bf16_f32 v154, v92, v93
    v_cvt_pk_bf16_f32 v155, v94, v95
    v_cvt_pk_bf16_f32 v156, v96, v97
    v_cvt_pk_bf16_f32 v157, v98, v99
    v_cvt_pk_bf16_f32 v158, v100, v101
    v_cvt_pk_bf16_f32 v159, v102, v103
    v_cvt_pk_bf16_f32 v160, v104, v105
    v_cvt_pk_bf16_f32 v161, v106, v107
    v_cvt_pk_bf16_f32 v162, v108, v109
    v_cvt_pk_bf16_f32 v163, v110, v111
    v_cvt_pk_bf16_f32 v164, v112, v113
    v_cvt_pk_bf16_f32 v165, v114, v115
    v_cvt_pk_bf16_f32 v166, v116, v117
    v_cvt_pk_bf16_f32 v167, v118, v119
    s_mov_b64 exec, s[46:47]
    v_mov_b32 v158, v232
    v_mov_b32 v159, v233
    v_mov_b32 v166, v234
    v_mov_b32 v167, v235
    s_mov_b64 exec, -1
    v_cvt_pk_bf16_f32 v232, v120, v136
    v_cvt_pk_bf16_f32 v233, v121, v137
    v_cvt_pk_bf16_f32 v234, v122, v138
    v_cvt_pk_bf16_f32 v235, v123, v139
    v_cvt_pk_bf16_f32 v236, v124, v140
    v_cvt_pk_bf16_f32 v237, v125, v141
    v_cvt_pk_bf16_f32 v238, v126, v142
    v_cvt_pk_bf16_f32 v239, v127, v143
    v_cvt_pk_bf16_f32 v240, v128, v144
    v_cvt_pk_bf16_f32 v241, v129, v145
    v_cvt_pk_bf16_f32 v242, v130, v146
    v_cvt_pk_bf16_f32 v243, v131, v147
    v_cvt_pk_bf16_f32 v244, v132, v148
    v_mov_b32 v216, 0
    v_mov_b32 v217, 0
    v_mov_b32 v218, 0
    v_mov_b32 v219, 0
    s_nop 1
    v_mfma_f32_32x32x16_bf16 v[24:39], v[216:219], v[216:219], 0
    v_mfma_f32_32x32x16_bf16 v[56:71], v[216:219], v[216:219], 0
    v_mfma_f32_32x32x16_bf16 v[40:55], v[216:219], v[216:219], 0
    v_mfma_f32_32x32x16_bf16 v[72:87], v[216:219], v[216:219], 0
    s_waitcnt lgkmcnt(0)
    s_mov_b32 s37, s39
    s_mov_b32 s38, 0
    s_barrier
    s_branch L_groups
L_slow:
    s_waitcnt vmcnt(0)
    v_lshlrev_b32 v13, 4, v0
    ds_write_b128 v13, v[200:203] offset:0
    ds_write_b128 v13, v[204:207] offset:8192
    ds_write_b128 v13, v[208:211] offset:16384
    ds_write_b128 v13, v[212:215] offset:24576
    s_waitcnt lgkmcnt(0)
    s_barrier
    s_mul_i32 s30, s51, 9216
    s_add_u32 s30, s30, 51200
    v_lshlrev_b32 v7, 4, v2
    v_add_u32 v7, s30, v7
    s_lshl_b32 s52, s32, 11
    s_add_u32 s52, s52, 34816
    s_mul_i32 s35, s53, 8000
    s_lshl_b32 s36, s51, 2
    s_add_u32 s35, s35, s36
    v_lshlrev_b32 v14, 5, v1
    v_mov_b32 v224, 0
    v_mov_b32 v225, 0
    v_mov_b32 v226, 0
    v_mov_b32 v227, 0
    buffer_load_dword v224, v14, s[20:23], s35 offen offset:0
    buffer_load_dword v225, v14, s[20:23], s35 offen offset:2048
    s_add_u32 s35, s35, 4096
    buffer_load_dword v226, v14, s[20:23], s35 offen offset:0
    s_add_u32 s35, s35, 2048
    v_cmp_gt_u32_e64 s[42:43], 58, v1
    s_mov_b64 exec, s[42:43]
    buffer_load_dword v227, v14, s[20:23], s35 offen offset:0
    s_mov_b64 exec, -1
    s_waitcnt vmcnt(0)
    s_mov_b32 s38, 0
L_chunk:
    v_lshrrev_b32 v88, 16, v224
    v_and_b32 v96, 0xffff, v224
    v_add_u32 v13, 0, v1
    v_mul_u32_u24 v13, 3200, v13
    v_add_u32 v96, v96, v13
    v_lshrrev_b32 v89, 16, v225
    v_and_b32 v97, 0xffff, v225
    v_add_u32 v13, 64, v1
    v_mul_u32_u24 v13, 3200, v13
    v_add_u32 v97, v97, v13
    v_lshrrev_b32 v90, 16, v226
    v_and_b32 v98, 0xffff, v226
    v_add_u32 v13, 128, v1
    v_mul_u32_u24 v13, 3200, v13
    v_add_u32 v98, v98, v13
    v_lshrrev_b32 v91, 16, v227
    v_and_b32 v99, 0xffff, v227
    v_add_u32 v13, 192, v1
    v_mul_u32_u24 v13, 3200, v13
    v_add_u32 v99, v99, v13
    v_add_u32 v101, v88, v89
    v_add3_u32 v101, v101, v90, v91
    v_mov_b32 v100, v101
    s_nop 1
    v_add_u32_dpp v100, v100, v100 row_shr:1 row_mask:0xf bank_mask:0xf bound_ctrl:0
    s_nop 1
    v_add_u32_dpp v100, v100, v100 row_shr:2 row_mask:0xf bank_mask:0xf bound_ctrl:0
    s_nop 1
    v_add_u32_dpp v100, v100, v100 row_shr:4 row_mask:0xf bank_mask:0xf bound_ctrl:0
    s_nop 1
    v_add_u32_dpp v100, v100, v100 row_shr:8 row_mask:0xf bank_mask:0xf bound_ctrl:0
    s_nop 1
    v_add_u32_dpp v100, v100, v100 row_bcast:15 row_mask:0xa bank_mask:0xf
    s_nop 1
    v_add_u32_dpp v100, v100, v100 row_bcast:31 row_mask:0xc bank_mask:0xf
    s_nop 1
    v_readlane_b32 s37, v100, 63
    v_sub_u32 v92, v100, v101
    v_add_u32 v93, v92, v88
    v_add_u32 v94, v93, v89
    v_add_u32 v95, v94, v90
    s_sub_u32 s39, s37, s38
    s_min_u32 s39, s39, 512
    s_add_u32 s35, s38, 512
    v_sub_u32 v104, s38, v92
    v_max_i32 v104, 0, v104
    v_sub_u32 v105, s35, v92
    v_min_i32 v105, v105, v88
    v_subrev_u32 v106, s38, v92
    v_add_u32 v106, v106, v104
    v_lshlrev_b32 v106, 2, v106
    v_add_u32 v106, s52, v106
    v_add_u32 v107, v96, v104
L_fill_4:
    v_cmp_lt_i32 vcc, v104, v105
    s_and_saveexec_b64 s[42:43], vcc
    s_cbranch_execz L_fill_end_5
    ds_write_b32 v106, v107
    v_add_u32 v104, 1, v104
    v_add_u32 v106, 4, v106
    v_add_u32 v107, 1, v107
    s_mov_b64 exec, s[42:43]
    s_branch L_fill_4
L_fill_end_5:
    s_mov_b64 exec, s[42:43]
    v_sub_u32 v104, s38, v93
    v_max_i32 v104, 0, v104
    v_sub_u32 v105, s35, v93
    v_min_i32 v105, v105, v89
    v_subrev_u32 v106, s38, v93
    v_add_u32 v106, v106, v104
    v_lshlrev_b32 v106, 2, v106
    v_add_u32 v106, s52, v106
    v_add_u32 v107, v97, v104
L_fill_6:
    v_cmp_lt_i32 vcc, v104, v105
    s_and_saveexec_b64 s[42:43], vcc
    s_cbranch_execz L_fill_end_7
    ds_write_b32 v106, v107
    v_add_u32 v104, 1, v104
    v_add_u32 v106, 4, v106
    v_add_u32 v107, 1, v107
    s_mov_b64 exec, s[42:43]
    s_branch L_fill_6
L_fill_end_7:
    s_mov_b64 exec, s[42:43]
    v_sub_u32 v104, s38, v94
    v_max_i32 v104, 0, v104
    v_sub_u32 v105, s35, v94
    v_min_i32 v105, v105, v90
    v_subrev_u32 v106, s38, v94
    v_add_u32 v106, v106, v104
    v_lshlrev_b32 v106, 2, v106
    v_add_u32 v106, s52, v106
    v_add_u32 v107, v98, v104
L_fill_8:
    v_cmp_lt_i32 vcc, v104, v105
    s_and_saveexec_b64 s[42:43], vcc
    s_cbranch_execz L_fill_end_9
    ds_write_b32 v106, v107
    v_add_u32 v104, 1, v104
    v_add_u32 v106, 4, v106
    v_add_u32 v107, 1, v107
    s_mov_b64 exec, s[42:43]
    s_branch L_fill_8
L_fill_end_9:
    s_mov_b64 exec, s[42:43]
    v_sub_u32 v104, s38, v95
    v_max_i32 v104, 0, v104
    v_sub_u32 v105, s35, v95
    v_min_i32 v105, v105, v91
    v_subrev_u32 v106, s38, v95
    v_add_u32 v106, v106, v104
    v_lshlrev_b32 v106, 2, v106
    v_add_u32 v106, s52, v106
    v_add_u32 v107, v99, v104
L_fill_10:
    v_cmp_lt_i32 vcc, v104, v105
    s_and_saveexec_b64 s[42:43], vcc
    s_cbranch_execz L_fill_end_11
    ds_write_b32 v106, v107
    v_add_u32 v104, 1, v104
    v_add_u32 v106, 4, v106
    v_add_u32 v107, 1, v107
    s_mov_b64 exec, s[42:43]
    s_branch L_fill_10
L_fill_end_11:
    s_mov_b64 exec, s[42:43]
    s_waitcnt lgkmcnt(0)
    v_lshlrev_b32 v21, 2, v1
    v_add_u32 v21, s52, v21
    ds_read_b32 v108, v21 offset:0
    ds_read_b32 v109, v21 offset:256
    ds_read_b32 v110, v21 offset:512
    ds_read_b32 v111, v21 offset:768
    ds_read_b32 v112, v21 offset:1024
    ds_read_b32 v113, v21 offset:1280
    ds_read_b32 v114, v21 offset:1536
    ds_read_b32 v115, v21 offset:1792
    ds_read_b32 v116, v21 offset:2048
    s_waitcnt lgkmcnt(0)
    v_mov_b32 v184, 0
    v_mov_b32 v185, 0
    v_mov_b32 v186, 0
    v_mul_u32_u24 v108, 12, v108
    v_mov_b32 v188, 0
    v_mov_b32 v189, 0
    v_mov_b32 v190, 0
    v_mul_u32_u24 v109, 12, v109
    v_mov_b32 v192, 0
    v_mov_b32 v193, 0
    v_mov_b32 v194, 0
    v_mul_u32_u24 v110, 12, v110
    v_mov_b32 v196, 0
    v_mov_b32 v197, 0
    v_mov_b32 v198, 0
    v_mul_u32_u24 v111, 12, v111
    v_mov_b32 v200, 0
    v_mov_b32 v201, 0
    v_mov_b32 v202, 0
    v_mul_u32_u24 v112, 12, v112
    v_mov_b32 v204, 0
    v_mov_b32 v205, 0
    v_mov_b32 v206, 0
    v_mul_u32_u24 v113, 12, v113
    v_mov_b32 v208, 0
    v_mov_b32 v209, 0
    v_mov_b32 v210, 0
    v_mul_u32_u24 v114, 12, v114
    v_mov_b32 v212, 0
    v_mov_b32 v213, 0
    v_mov_b32 v214, 0
    v_mul_u32_u24 v115, 12, v115
    v_mov_b32 v228, 0
    v_mov_b32 v229, 0
    v_mov_b32 v230, 0
    v_mul_u32_u24 v116, 12, v116
    v_add_u32 v13, 0, v1
    v_cmp_gt_u32_e64 s[64:65], s39, v13
    s_mov_b64 exec, s[64:65]
    s_cbranch_execz L_gsk_12
    buffer_load_dwordx3 v[184:186], v108, s[24:27], 0 offen
L_gsk_12:
    s_mov_b64 exec, -1
    v_add_u32 v13, 64, v1
    v_cmp_gt_u32_e64 s[66:67], s39, v13
    s_mov_b64 exec, s[66:67]
    s_cbranch_execz L_gsk_13
    buffer_load_dwordx3 v[188:190], v109, s[24:27], 0 offen
L_gsk_13:
    s_mov_b64 exec, -1
    v_add_u32 v13, 128, v1
    v_cmp_gt_u32_e64 s[68:69], s39, v13
    s_mov_b64 exec, s[68:69]
    s_cbranch_execz L_gsk_14
    buffer_load_dwordx3 v[192:194], v110, s[24:27], 0 offen
L_gsk_14:
    s_mov_b64 exec, -1
    v_add_u32 v13, 192, v1
    v_cmp_gt_u32_e64 s[70:71], s39, v13
    s_mov_b64 exec, s[70:71]
    s_cbranch_execz L_gsk_15
    buffer_load_dwordx3 v[196:198], v111, s[24:27], 0 offen
L_gsk_15:
    s_mov_b64 exec, -1
    v_add_u32 v13, 256, v1
    v_cmp_gt_u32_e64 s[72:73], s39, v13
    s_mov_b64 exec, s[72:73]
    s_cbranch_execz L_gsk_16
    buffer_load_dwordx3 v[200:202], v112, s[24:27], 0 offen
L_gsk_16:
    s_mov_b64 exec, -1
    v_add_u32 v13, 320, v1
    v_cmp_gt_u32_e64 s[74:75], s39, v13
    s_mov_b64 exec, s[74:75]
    s_cbranch_execz L_gsk_17
    buffer_load_dwordx3 v[204:206], v113, s[24:27], 0 offen
L_gsk_17:
    s_mov_b64 exec, -1
    v_add_u32 v13, 384, v1
    v_cmp_gt_u32_e64 s[76:77], s39, v13
    s_mov_b64 exec, s[76:77]
    s_cbranch_execz L_gsk_18
    buffer_load_dwordx3 v[208:210], v114, s[24:27], 0 offen
L_gsk_18:
    s_mov_b64 exec, -1
    v_add_u32 v13, 448, v1
    v_cmp_gt_u32_e64 s[78:79], s39, v13
    s_mov_b64 exec, s[78:79]
    s_cbranch_execz L_gsk_19
    buffer_load_dwordx3 v[212:214], v115, s[24:27], 0 offen
L_gsk_19:
    s_mov_b64 exec, -1
    v_add_u32 v13, 512, v1
    v_cmp_gt_u32_e64 s[80:81], s39, v13
    s_mov_b64 exec, s[80:81]
    s_cbranch_execz L_gsk_20
    buffer_load_dwordx3 v[228:230], v116, s[24:27], 0 offen
L_gsk_20:
    s_mov_b64 exec, -1
    s_cmp_lg_u32 s38, 0
    s_cbranch_scc1 L_p1_done_21
    ds_read_b128 v[216:219], v8 offset:16384
    ds_read_b128 v[220:223], v8 offset:17408
    ds_read_b128 v[224:227], v8 offset:18432
    ds_read_b128 v[228:231], v8 offset:19456
    s_waitcnt lgkmcnt(0)
    v_mfma_f32_32x32x16_bf16 v[88:103], v[168:171], v[216:219], 0
    v_mfma_f32_32x32x16_bf16 v[88:103], v[172:175], v[220:223], v[88:103]
    v_mfma_f32_32x32x16_bf16 v[88:103], v[176:179], v[224:227], v[88:103]
    v_mfma_f32_32x32x16_bf16 v[88:103], v[180:183], v[228:231], v[88:103]
    ds_read_b128 v[216:219], v8 offset:20480
    ds_read_b128 v[220:223], v8 offset:21504
    ds_read_b128 v[224:227], v8 offset:22528
    ds_read_b128 v[228:231], v8 offset:23552
    s_waitcnt lgkmcnt(0)
    v_mfma_f32_32x32x16_bf16 v[104:119], v[168:171], v[216:219], 0
    v_mfma_f32_32x32x16_bf16 v[104:119], v[172:175], v[220:223], v[104:119]
    v_mfma_f32_32x32x16_bf16 v[104:119], v[176:179], v[224:227], v[104:119]
    v_mfma_f32_32x32x16_bf16 v[104:119], v[180:183], v[228:231], v[104:119]
    ds_read_b128 v[216:219], v8 offset:24576
    ds_read_b128 v[220:223], v8 offset:25600
    ds_read_b128 v[224:227], v8 offset:26624
    ds_read_b128 v[228:231], v8 offset:27648
    s_waitcnt lgkmcnt(0)
    v_mfma_f32_32x32x16_bf16 v[120:135], v[168:171], v[216:219], 0
    v_mfma_f32_32x32x16_bf16 v[120:135], v[172:175], v[220:223], v[120:135]
    v_mfma_f32_32x32x16_bf16 v[120:135], v[176:179], v[224:227], v[120:135]
    v_mfma_f32_32x32x16_bf16 v[120:135], v[180:183], v[228:231], v[120:135]
    ds_read_b128 v[216:219], v8 offset:28672
    ds_read_b128 v[220:223], v8 offset:29696
    ds_read_b128 v[224:227], v8 offset:30720
    ds_read_b128 v[228:231], v8 offset:31744
    s_waitcnt lgkmcnt(0)
    v_mfma_f32_32x32x16_bf16 v[136:151], v[168:171], v[216:219], 0
    v_mfma_f32_32x32x16_bf16 v[136:151], v[172:175], v[220:223], v[136:151]
    v_mfma_f32_32x32x16_bf16 v[136:151], v[176:179], v[224:227], v[136:151]
    v_mfma_f32_32x32x16_bf16 v[136:151], v[180:183], v[228:231], v[136:151]
    s_nop 7
    s_nop 7
    v_mul_f32 v88, 0xbfb8aa3b, v88
    v_mul_f32 v89, 0xbfb8aa3b, v89
    v_mul_f32 v90, 0xbfb8aa3b, v90
    v_mul_f32 v91, 0xbfb8aa3b, v91
    v_mul_f32 v92, 0xbfb8aa3b, v92
    v_mul_f32 v93, 0xbfb8aa3b, v93
    v_mul_f32 v94, 0xbfb8aa3b, v94
    v_mul_f32 v95, 0xbfb8aa3b, v95
    v_mul_f32 v96, 0xbfb8aa3b, v96
    v_mul_f32 v97, 0xbfb8aa3b, v97
    v_mul_f32 v98, 0xbfb8aa3b, v98
    v_mul_f32 v99, 0xbfb8aa3b, v99
    v_mul_f32 v100, 0xbfb8aa3b, v100
    v_mul_f32 v101, 0xbfb8aa3b, v101
    v_mul_f32 v102, 0xbfb8aa3b, v102
    v_mul_f32 v103, 0xbfb8aa3b, v103
    v_mul_f32 v104, 0xbfb8aa3b, v104
    v_mul_f32 v105, 0xbfb8aa3b, v105
    v_mul_f32 v106, 0xbfb8aa3b, v106
    v_mul_f32 v107, 0xbfb8aa3b, v107
    v_mul_f32 v108, 0xbfb8aa3b, v108
    v_mul_f32 v109, 0xbfb8aa3b, v109
    v_mul_f32 v110, 0xbfb8aa3b, v110
    v_mul_f32 v111, 0xbfb8aa3b, v111
    v_mul_f32 v112, 0xbfb8aa3b, v112
    v_mul_f32 v113, 0xbfb8aa3b, v113
    v_mul_f32 v114, 0xbfb8aa3b, v114
    v_mul_f32 v115, 0xbfb8aa3b, v115
    v_mul_f32 v116, 0xbfb8aa3b, v116
    v_mul_f32 v117, 0xbfb8aa3b, v117
    v_mul_f32 v118, 0xbfb8aa3b, v118
    v_mul_f32 v119, 0xbfb8aa3b, v119
    v_cvt_pk_bf16_f32 v152, v88, v89
    v_cvt_pk_bf16_f32 v153, v90, v91
    v_cvt_pk_bf16_f32 v154, v92, v93
    v_cvt_pk_bf16_f32 v155, v94, v95
    v_cvt_pk_bf16_f32 v156, v96, v97
    v_cvt_pk_bf16_f32 v157, v98, v99
    v_cvt_pk_bf16_f32 v158, v100, v101
    v_cvt_pk_bf16_f32 v159, v102, v103
    v_cvt_pk_bf16_f32 v160, v104, v105
    v_cvt_pk_bf16_f32 v161, v106, v107
    v_cvt_pk_bf16_f32 v162, v108, v109
    v_cvt_pk_bf16_f32 v163, v110, v111
    v_cvt_pk_bf16_f32 v164, v112, v113
    v_cvt_pk_bf16_f32 v165, v114, v115
    v_cvt_pk_bf16_f32 v166, v116, v117
    v_cvt_pk_bf16_f32 v167, v118, v119
    s_mov_b64 exec, s[46:47]
    v_mov_b32 v158, v232
    v_mov_b32 v159, v233
    v_mov_b32 v166, v234
    v_mov_b32 v167, v235
    s_mov_b64 exec, -1
    v_cvt_pk_bf16_f32 v232, v120, v136
    v_cvt_pk_bf16_f32 v233, v121, v137
    v_cvt_pk_bf16_f32 v234, v122, v138
    v_cvt_pk_bf16_f32 v235, v123, v139
    v_cvt_pk_bf16_f32 v236, v124, v140
    v_cvt_pk_bf16_f32 v237, v125, v141
    v_cvt_pk_bf16_f32 v238, v126, v142
    v_cvt_pk_bf16_f32 v239, v127, v143
    v_cvt_pk_bf16_f32 v240, v128, v144
    v_cvt_pk_bf16_f32 v241, v129, v145
    v_cvt_pk_bf16_f32 v242, v130, v146
    v_cvt_pk_bf16_f32 v243, v131, v147
    v_cvt_pk_bf16_f32 v244, v132, v148
    v_mov_b32 v216, 0
    v_mov_b32 v217, 0
    v_mov_b32 v218, 0
    v_mov_b32 v219, 0
    s_nop 1
    v_mfma_f32_32x32x16_bf16 v[24:39], v[216:219], v[216:219], 0
    v_mfma_f32_32x32x16_bf16 v[56:71], v[216:219], v[216:219], 0
    v_mfma_f32_32x32x16_bf16 v[40:55], v[216:219], v[216:219], 0
    v_mfma_f32_32x32x16_bf16 v[72:87], v[216:219], v[216:219], 0
L_p1_done_21:
    v_lshlrev_b32 v13, 4, v1
    v_add_u32 v13, s30, v13
    s_waitcnt vmcnt(0)
    v_lshrrev_b32 v187, 12, v186
    v_and_b32 v187, 0x1f0, v187
    v_and_b32 v186, 0xffff, v186
    v_lshlrev_b32 v186, 7, v186
    s_not_b64 exec, s[64:65]
    v_mov_b32 v186, 0x7fffff00
    v_mov_b32 v187, 496
    s_mov_b64 exec, -1
    ds_write_b128 v13, v[184:187] offset:0
    v_lshrrev_b32 v191, 12, v190
    v_and_b32 v191, 0x1f0, v191
    v_and_b32 v190, 0xffff, v190
    v_lshlrev_b32 v190, 7, v190
    s_not_b64 exec, s[66:67]
    v_mov_b32 v190, 0x7fffff00
    v_mov_b32 v191, 496
    s_mov_b64 exec, -1
    ds_write_b128 v13, v[188:191] offset:1024
    v_lshrrev_b32 v195, 12, v194
    v_and_b32 v195, 0x1f0, v195
    v_and_b32 v194, 0xffff, v194
    v_lshlrev_b32 v194, 7, v194
    s_not_b64 exec, s[68:69]
    v_mov_b32 v194, 0x7fffff00
    v_mov_b32 v195, 496
    s_mov_b64 exec, -1
    ds_write_b128 v13, v[192:195] offset:2048
    v_lshrrev_b32 v199, 12, v198
    v_and_b32 v199, 0x1f0, v199
    v_and_b32 v198, 0xffff, v198
    v_lshlrev_b32 v198, 7, v198
    s_not_b64 exec, s[70:71]
    v_mov_b32 v198, 0x7fffff00
    v_mov_b32 v199, 496
    s_mov_b64 exec, -1
    ds_write_b128 v13, v[196:199] offset:3072
    v_lshrrev_b32 v203, 12, v202
    v_and_b32 v203, 0x1f0, v203
    v_and_b32 v202, 0xffff, v202
    v_lshlrev_b32 v202, 7, v202
    s_not_b64 exec, s[72:73]
    v_mov_b32 v202, 0x7fffff00
    v_mov_b32 v203, 496
    s_mov_b64 exec, -1
    ds_write_b128 v13, v[200:203] offset:4096
    v_lshrrev_b32 v207, 12, v206
    v_and_b32 v207, 0x1f0, v207
    v_and_b32 v206, 0xffff, v206
    v_lshlrev_b32 v206, 7, v206
    s_not_b64 exec, s[74:75]
    v_mov_b32 v206, 0x7fffff00
    v_mov_b32 v207, 496
    s_mov_b64 exec, -1
    ds_write_b128 v13, v[204:207] offset:5120
    v_lshrrev_b32 v211, 12, v210
    v_and_b32 v211, 0x1f0, v211
    v_and_b32 v210, 0xffff, v210
    v_lshlrev_b32 v210, 7, v210
    s_not_b64 exec, s[76:77]
    v_mov_b32 v210, 0x7fffff00
    v_mov_b32 v211, 496
    s_mov_b64 exec, -1
    ds_write_b128 v13, v[208:211] offset:6144
    v_lshrrev_b32 v215, 12, v214
    v_and_b32 v215, 0x1f0, v215
    v_and_b32 v214, 0xffff, v214
    v_lshlrev_b32 v214, 7, v214
    s_not_b64 exec, s[78:79]
    v_mov_b32 v214, 0x7fffff00
    v_mov_b32 v215, 496
    s_mov_b64 exec, -1
    ds_write_b128 v13, v[212:215] offset:7168
    v_lshrrev_b32 v231, 12, v230
    v_and_b32 v231, 0x1f0, v231
    v_and_b32 v230, 0xffff, v230
    v_lshlrev_b32 v230, 7, v230
    s_not_b64 exec, s[80:81]
    v_mov_b32 v230, 0x7fffff00
    v_mov_b32 v231, 496
    s_mov_b64 exec, -1
    ds_write_b128 v13, v[228:231] offset:8192
    s_waitcnt lgkmcnt(0)
    s_add_u32 s40, s39, 31
    s_lshr_b32 s40, s40, 5
L_groups:
    s_cmp_eq_u32 s40, 0
    s_cbranch_scc1 L_groups_done
    ds_read_b64 v[18:19], v7 offset:8
    ds_write_b16 v9, v11
    ds_write_b16 v20, v11
    s_waitcnt lgkmcnt(0)
    v_add_u32 v12, v18, v3
    buffer_load_dwordx4 v[168:171], v12, s[8:11], 0 offen offset:0
    buffer_load_dwordx4 v[172:175], v12, s[8:11], 0 offen offset:32
    buffer_load_dwordx4 v[176:179], v12, s[8:11], 0 offen offset:64
    buffer_load_dwordx4 v[180:183], v12, s[8:11], 0 offen offset:96
    v_add_u32 v21, v19, v4
    ds_read_b128 v[200:203], v21
    ds_read_b128 v[204:207], v21 offset:1024
    s_mov_b64 exec, s[46:47]
    ds_read_b64 v[206:207], v7
    s_mov_b64 exec, -1
    v_lshl_add_u32 v9, v19, 2, v5
    ds_write_b16 v9, v10
    ds_read_b64 v[18:19], v7 offset:520
    v_add_u32 v16, 512, v7
    v_mov_b32 v208, 0
    v_mov_b32 v212, 0
    v_mov_b32 v209, 0
    v_mov_b32 v213, 0
    v_mov_b32 v210, 0
    v_mov_b32 v214, 0
    v_mov_b32 v211, 0
    v_mov_b32 v215, 0
    v_mov_b32 v104, 0
    v_mov_b32 v136, 0
    v_mov_b32 v105, 0
    v_mov_b32 v137, 0
    v_mov_b32 v106, 0
    v_mov_b32 v138, 0
    v_mov_b32 v107, 0
    v_mov_b32 v139, 0
    v_mov_b32 v108, 0
    v_mov_b32 v140, 0
    v_mov_b32 v109, 0
    v_mov_b32 v141, 0
    v_mov_b32 v110, 0
    v_mov_b32 v142, 0
    v_mov_b32 v111, 0
    v_mov_b32 v143, 0
    s_waitcnt lgkmcnt(0)
    v_add_u32 v12, v18, v3
    buffer_load_dwordx4 v[184:187], v12, s[8:11], 0 offen offset:0
    buffer_load_dwordx4 v[188:191], v12, s[8:11], 0 offen offset:32
    buffer_load_dwordx4 v[192:195], v12, s[8:11], 0 offen offset:64
    buffer_load_dwordx4 v[196:199], v12, s[8:11], 0 offen offset:96
    s_waitcnt vmcnt(4)
    v_mfma_f32_32x32x16_bf16 v[88:103], v[200:203], v[152:155], 0
    v_mfma_f32_32x32x16_bf16 v[88:103], v[204:207], v[156:159], v[88:103]
    ds_read_b128 v[216:219], v8 offset:0
    ds_read_b128 v[220:223], v8 offset:1024
    ds_read_b128 v[224:227], v8 offset:2048
    ds_read_b128 v[228:231], v8 offset:3072
    s_waitcnt lgkmcnt(0)
    v_mfma_f32_32x32x16_bf16 v[88:103], v[168:171], v[216:219], v[88:103]
    v_mfma_f32_32x32x16_bf16 v[88:103], v[172:175], v[220:223], v[88:103]
    v_mfma_f32_32x32x16_bf16 v[88:103], v[176:179], v[224:227], v[88:103]
    v_mfma_f32_32x32x16_bf16 v[88:103], v[180:183], v[228:231], v[88:103]
    ds_read_b128 v[216:219], v8 offset:8192
    ds_read_b128 v[220:223], v8 offset:9216
    ds_read_b128 v[224:227], v8 offset:10240
    ds_read_b128 v[228:231], v8 offset:11264
    s_waitcnt lgkmcnt(0)
    v_mfma_f32_32x32x16_bf16 v[120:135], v[168:171], v[216:219], 0
    v_mfma_f32_32x32x16_bf16 v[120:135], v[172:175], v[220:223], v[120:135]
    v_mfma_f32_32x32x16_bf16 v[120:135], v[176:179], v[224:227], v[120:135]
    v_mfma_f32_32x32x16_bf16 v[120:135], v[180:183], v[228:231], v[120:135]
    s_nop 7
    s_nop 7
    s_mov_b32 s41, 0
    s_lshr_b32 s50, s32, 2
L_group:
    v_add_u32 v21, v19, v4
    v_lshl_add_u32 v20, v19, 2, v5
    v_exp_f32 v88, v88
    ds_read_b128 v[216:219], v8 offset:4096
    v_exp_f32 v89, v89
    v_mfma_f32_32x32x16_bf16 v[40:55], v[208:211], v[104:107], v[40:55]
    ds_read_b128 v[220:223], v8 offset:5120
    v_exp_f32 v90, v90
    ds_read_b128 v[224:227], v8 offset:6144
    v_exp_f32 v91, v91
    ds_read_b128 v[228:231], v8 offset:7168
    v_exp_f32 v92, v92
    v_exp_f32 v93, v93
    v_mfma_f32_32x32x16_bf16 v[40:55], v[212:215], v[108:111], v[40:55]
    v_exp_f32 v94, v94
    v_exp_f32 v95, v95
    v_exp_f32 v96, v96
    v_exp_f32 v97, v97
    v_mfma_f32_32x32x16_bf16 v[72:87], v[208:211], v[136:139], v[72:87]
    v_exp_f32 v98, v98
    v_exp_f32 v99, v99
    v_exp_f32 v100, v100
    v_exp_f32 v101, v101
    v_mfma_f32_32x32x16_bf16 v[72:87], v[212:215], v[140:143], v[72:87]
    ds_read_b128 v[208:211], v6
    ds_read_b128 v[212:215], v6 offset:32
    ds_write_b16 v9, v11
    ds_write_b16 v20, v10
    v_exp_f32 v102, v102
    v_exp_f32 v103, v103
    v_add_f32 v88, 1.0, v88
    v_add_f32 v89, 1.0, v89
    v_add_f32 v90, 1.0, v90
    v_add_f32 v91, 1.0, v91
    v_mfma_f32_32x32x16_bf16 v[104:119], v[200:203], v[160:163], 0
    v_add_f32 v92, 1.0, v92
    v_add_f32 v93, 1.0, v93
    v_add_f32 v94, 1.0, v94
    v_add_f32 v95, 1.0, v95
    v_add_f32 v96, 1.0, v96
    v_add_f32 v97, 1.0, v97
    v_mfma_f32_32x32x16_bf16 v[104:119], v[204:207], v[164:167], v[104:119]
    ds_read_b128 v[200:203], v21
    ds_read_b128 v[204:207], v21 offset:1024
    s_mov_b64 exec, s[46:47]
    ds_read_b64 v[206:207], v16
    s_mov_b64 exec, -1
    ds_read_b64 v[18:19], v16 offset:520
    v_add_u32 v16, 512, v16
    v_add_f32 v98, 1.0, v98
    v_add_f32 v99, 1.0, v99
    v_add_f32 v100, 1.0, v100
    v_add_f32 v101, 1.0, v101
    v_add_f32 v102, 1.0, v102
    v_add_f32 v103, 1.0, v103
    s_waitcnt lgkmcnt(11)
    v_mfma_f32_32x32x16_bf16 v[104:119], v[168:171], v[216:219], v[104:119]
    ds_read_b128 v[216:219], v8 offset:12288
    v_rcp_f32 v88, v88
    v_rcp_f32 v89, v89
    v_rcp_f32 v90, v90
    v_rcp_f32 v91, v91
    v_rcp_f32 v92, v92
    v_rcp_f32 v93, v93
    s_waitcnt lgkmcnt(11)
    v_mfma_f32_32x32x16_bf16 v[104:119], v[172:175], v[220:223], v[104:119]
    ds_read_b128 v[220:223], v8 offset:13312
    v_rcp_f32 v94, v94
    v_rcp_f32 v95, v95
    v_rcp_f32 v96, v96
    v_rcp_f32 v97, v97
    v_rcp_f32 v98, v98
    v_rcp_f32 v99, v99
    s_waitcnt lgkmcnt(11)
    v_mfma_f32_32x32x16_bf16 v[104:119], v[176:179], v[224:227], v[104:119]
    ds_read_b128 v[224:227], v8 offset:14336
    v_rcp_f32 v100, v100
    v_rcp_f32 v101, v101
    v_rcp_f32 v102, v102
    v_rcp_f32 v103, v103
    v_mul_f32 v120, v88, v120
    v_mul_f32 v121, v89, v121
    s_waitcnt lgkmcnt(11)
    v_mfma_f32_32x32x16_bf16 v[104:119], v[180:183], v[228:231], v[104:119]
    ds_read_b128 v[228:231], v8 offset:15360
    v_mul_f32 v122, v90, v122
    v_mul_f32 v123, v91, v123
    v_mul_f32 v124, v92, v124
    v_mul_f32 v125, v93, v125
    v_mul_f32 v126, v94, v126
    v_mul_f32 v127, v95, v127
    v_mul_f32 v128, v96, v128
    s_waitcnt lgkmcnt(3)
    v_mfma_f32_32x32x16_bf16 v[136:151], v[168:171], v[216:219], 0
    v_mul_f32 v129, v97, v129
    v_mul_f32 v130, v98, v130
    v_mul_f32 v131, v99, v131
    v_mul_f32 v132, v100, v132
    v_mul_f32 v133, v101, v133
    v_mul_f32 v134, v102, v134
    s_waitcnt lgkmcnt(2)
    v_mfma_f32_32x32x16_bf16 v[136:151], v[172:175], v[220:223], v[136:151]
    v_mul_f32 v135, v103, v135
    v_cvt_pk_bf16_f32 v88, v88, v89
    v_cvt_pk_bf16_f32 v89, v90, v91
    v_cvt_pk_bf16_f32 v90, v92, v93
    v_cvt_pk_bf16_f32 v91, v94, v95
    v_cvt_pk_bf16_f32 v92, v96, v97
    s_waitcnt lgkmcnt(1)
    v_mfma_f32_32x32x16_bf16 v[136:151], v[176:179], v[224:227], v[136:151]
    v_cvt_pk_bf16_f32 v93, v98, v99
    v_cvt_pk_bf16_f32 v94, v100, v101
    v_cvt_pk_bf16_f32 v95, v102, v103
    v_cvt_pk_bf16_f32 v120, v120, v121
    v_cvt_pk_bf16_f32 v121, v122, v123
    v_cvt_pk_bf16_f32 v122, v124, v125
    s_waitcnt lgkmcnt(0)
    v_mfma_f32_32x32x16_bf16 v[136:151], v[180:183], v[228:231], v[136:151]
    v_cvt_pk_bf16_f32 v123, v126, v127
    v_cvt_pk_bf16_f32 v124, v128, v129
    v_cvt_pk_bf16_f32 v125, v130, v131
    v_cvt_pk_bf16_f32 v126, v132, v133
    v_cvt_pk_bf16_f32 v127, v134, v135
    v_exp_f32 v104, v104
    ds_read_b128 v[216:219], v8
    v_exp_f32 v105, v105
    v_mfma_f32_32x32x16_bf16 v[24:39], v[208:211], v[88:91], v[24:39]
    ds_read_b128 v[220:223], v8 offset:1024
    v_exp_f32 v106, v106
    ds_read_b128 v[224:227], v8 offset:2048
    v_exp_f32 v107, v107
    ds_read_b128 v[228:231], v8 offset:3072
    v_exp_f32 v108, v108
    v_add_u32 v12, v18, v3
    v_exp_f32 v109, v109
    v_mfma_f32_32x32x16_bf16 v[24:39], v[212:215], v[92:95], v[24:39]
    buffer_load_dwordx4 v[168:171], v12, s[8:11], 0 offen
    buffer_load_dwordx4 v[172:175], v12, s[8:11], 0 offen offset:32
    buffer_load_dwordx4 v[176:179], v12, s[8:11], 0 offen offset:64
    buffer_load_dwordx4 v[180:183], v12, s[8:11], 0 offen offset:96
    v_exp_f32 v110, v110
    v_exp_f32 v111, v111
    v_exp_f32 v112, v112
    v_exp_f32 v113, v113
    v_mfma_f32_32x32x16_bf16 v[56:71], v[208:211], v[120:123], v[56:71]
    v_exp_f32 v114, v114
    v_exp_f32 v115, v115
    v_exp_f32 v116, v116
    v_exp_f32 v117, v117
    v_mfma_f32_32x32x16_bf16 v[56:71], v[212:215], v[124:127], v[56:71]
    v_exp_f32 v118, v118
    v_exp_f32 v119, v119
    v_add_f32 v104, 1.0, v104
    v_add_f32 v105, 1.0, v105
    v_add_f32 v106, 1.0, v106
    v_add_f32 v107, 1.0, v107
    v_mfma_f32_32x32x16_bf16 v[88:103], v[200:203], v[152:155], 0
    v_add_f32 v108, 1.0, v108
    v_add_f32 v109, 1.0, v109
    v_add_f32 v110, 1.0, v110
    v_add_f32 v111, 1.0, v111
    v_add_f32 v112, 1.0, v112
    v_add_f32 v113, 1.0, v113
    v_mfma_f32_32x32x16_bf16 v[88:103], v[204:207], v[156:159], v[88:103]
    v_add_f32 v114, 1.0, v114
    v_add_f32 v115, 1.0, v115
    v_add_f32 v116, 1.0, v116
    v_add_f32 v117, 1.0, v117
    v_add_f32 v118, 1.0, v118
    v_add_f32 v119, 1.0, v119
    s_waitcnt vmcnt(7) lgkmcnt(3)
    v_mfma_f32_32x32x16_bf16 v[88:103], v[184:187], v[216:219], v[88:103]
    ds_read_b128 v[216:219], v8 offset:8192
    v_rcp_f32 v104, v104
    v_rcp_f32 v105, v105
    v_rcp_f32 v106, v106
    v_rcp_f32 v107, v107
    v_rcp_f32 v108, v108
    v_rcp_f32 v109, v109
    s_waitcnt vmcnt(6) lgkmcnt(3)
    v_mfma_f32_32x32x16_bf16 v[88:103], v[188:191], v[220:223], v[88:103]
    ds_read_b128 v[220:223], v8 offset:9216
    v_rcp_f32 v110, v110
    v_rcp_f32 v111, v111
    v_rcp_f32 v112, v112
    v_rcp_f32 v113, v113
    v_rcp_f32 v114, v114
    v_rcp_f32 v115, v115
    s_waitcnt vmcnt(5) lgkmcnt(3)
    v_mfma_f32_32x32x16_bf16 v[88:103], v[192:195], v[224:227], v[88:103]
    ds_read_b128 v[224:227], v8 offset:10240
    v_rcp_f32 v116, v116
    v_rcp_f32 v117, v117
    v_rcp_f32 v118, v118
    v_rcp_f32 v119, v119
    v_mul_f32 v136, v104, v136
    v_mul_f32 v137, v105, v137
    s_waitcnt vmcnt(4) lgkmcnt(3)
    v_mfma_f32_32x32x16_bf16 v[88:103], v[196:199], v[228:231], v[88:103]
    ds_read_b128 v[228:231], v8 offset:11264
    v_mul_f32 v138, v106, v138
    v_mul_f32 v139, v107, v139
    v_mul_f32 v140, v108, v140
    v_mul_f32 v141, v109, v141
    v_mul_f32 v142, v110, v142
    v_mul_f32 v143, v111, v143
    v_mul_f32 v144, v112, v144
    s_waitcnt lgkmcnt(3)
    v_mfma_f32_32x32x16_bf16 v[120:135], v[184:187], v[216:219], 0
    v_mul_f32 v145, v113, v145
    v_mul_f32 v146, v114, v146
    v_mul_f32 v147, v115, v147
    v_mul_f32 v148, v116, v148
    v_mul_f32 v149, v117, v149
    v_mul_f32 v150, v118, v150
    s_waitcnt lgkmcnt(2)
    v_mfma_f32_32x32x16_bf16 v[120:135], v[188:191], v[220:223], v[120:135]
    v_mul_f32 v151, v119, v151
    v_cvt_pk_bf16_f32 v104, v104, v105
    v_cvt_pk_bf16_f32 v105, v106, v107
    v_cvt_pk_bf16_f32 v106, v108, v109
    v_cvt_pk_bf16_f32 v107, v110, v111
    v_cvt_pk_bf16_f32 v108, v112, v113
    s_waitcnt lgkmcnt(1)
    v_mfma_f32_32x32x16_bf16 v[120:135], v[192:195], v[224:227], v[120:135]
    v_cvt_pk_bf16_f32 v109, v114, v115
    v_cvt_pk_bf16_f32 v110, v116, v117
    v_cvt_pk_bf16_f32 v111, v118, v119
    v_cvt_pk_bf16_f32 v136, v136, v137
    v_cvt_pk_bf16_f32 v137, v138, v139
    v_cvt_pk_bf16_f32 v138, v140, v141
    s_waitcnt lgkmcnt(0)
    v_mfma_f32_32x32x16_bf16 v[120:135], v[196:199], v[228:231], v[120:135]
    v_cvt_pk_bf16_f32 v139, v142, v143
    v_cvt_pk_bf16_f32 v140, v144, v145
    v_cvt_pk_bf16_f32 v141, v146, v147
    v_cvt_pk_bf16_f32 v142, v148, v149
    v_cvt_pk_bf16_f32 v143, v150, v151
    s_add_u32 s41, s41, 1
    s_cmp_ge_u32 s41, s40
    s_cbranch_scc1 L_drain
    v_add_u32 v21, v19, v4
    v_lshl_add_u32 v9, v19, 2, v5
    v_exp_f32 v88, v88
    ds_read_b128 v[216:219], v8 offset:4096
    v_exp_f32 v89, v89
    v_mfma_f32_32x32x16_bf16 v[40:55], v[208:211], v[104:107], v[40:55]
    ds_read_b128 v[220:223], v8 offset:5120
    v_exp_f32 v90, v90
    ds_read_b128 v[224:227], v8 offset:6144
    v_exp_f32 v91, v91
    ds_read_b128 v[228:231], v8 offset:7168
    v_exp_f32 v92, v92
    v_exp_f32 v93, v93
    v_mfma_f32_32x32x16_bf16 v[40:55], v[212:215], v[108:111], v[40:55]
    v_exp_f32 v94, v94
    v_exp_f32 v95, v95
    v_exp_f32 v96, v96
    v_exp_f32 v97, v97
    v_mfma_f32_32x32x16_bf16 v[72:87], v[208:211], v[136:139], v[72:87]
    v_exp_f32 v98, v98
    v_exp_f32 v99, v99
    v_exp_f32 v100, v100
    v_exp_f32 v101, v101
    v_mfma_f32_32x32x16_bf16 v[72:87], v[212:215], v[140:143], v[72:87]
    ds_read_b128 v[208:211], v6
    ds_read_b128 v[212:215], v6 offset:32
    ds_write_b16 v20, v11
    ds_write_b16 v9, v10
    v_exp_f32 v102, v102
    v_exp_f32 v103, v103
    v_add_f32 v88, 1.0, v88
    v_add_f32 v89, 1.0, v89
    v_add_f32 v90, 1.0, v90
    v_add_f32 v91, 1.0, v91
    v_mfma_f32_32x32x16_bf16 v[104:119], v[200:203], v[160:163], 0
    v_add_f32 v92, 1.0, v92
    v_add_f32 v93, 1.0, v93
    v_add_f32 v94, 1.0, v94
    v_add_f32 v95, 1.0, v95
    v_add_f32 v96, 1.0, v96
    v_add_f32 v97, 1.0, v97
    v_mfma_f32_32x32x16_bf16 v[104:119], v[204:207], v[164:167], v[104:119]
    ds_read_b128 v[200:203], v21
    ds_read_b128 v[204:207], v21 offset:1024
    s_mov_b64 exec, s[46:47]
    ds_read_b64 v[206:207], v16
    s_mov_b64 exec, -1
    ds_read_b64 v[18:19], v16 offset:520
    v_add_u32 v16, 512, v16
    v_add_f32 v98, 1.0, v98
    v_add_f32 v99, 1.0, v99
    v_add_f32 v100, 1.0, v100
    v_add_f32 v101, 1.0, v101
    v_add_f32 v102, 1.0, v102
    v_add_f32 v103, 1.0, v103
    s_waitcnt lgkmcnt(11)
    v_mfma_f32_32x32x16_bf16 v[104:119], v[184:187], v[216:219], v[104:119]
    ds_read_b128 v[216:219], v8 offset:12288
    v_rcp_f32 v88, v88
    v_rcp_f32 v89, v89
    v_rcp_f32 v90, v90
    v_rcp_f32 v91, v91
    v_rcp_f32 v92, v92
    v_rcp_f32 v93, v93
    s_waitcnt lgkmcnt(11)
    v_mfma_f32_32x32x16_bf16 v[104:119], v[188:191], v[220:223], v[104:119]
    ds_read_b128 v[220:223], v8 offset:13312
    v_rcp_f32 v94, v94
    v_rcp_f32 v95, v95
    v_rcp_f32 v96, v96
    v_rcp_f32 v97, v97
    v_rcp_f32 v98, v98
    v_rcp_f32 v99, v99
    s_waitcnt lgkmcnt(11)
    v_mfma_f32_32x32x16_bf16 v[104:119], v[192:195], v[224:227], v[104:119]
    ds_read_b128 v[224:227], v8 offset:14336
    v_rcp_f32 v100, v100
    v_rcp_f32 v101, v101
    v_rcp_f32 v102, v102
    v_rcp_f32 v103, v103
    v_mul_f32 v120, v88, v120
    v_mul_f32 v121, v89, v121
    s_waitcnt lgkmcnt(11)
    v_mfma_f32_32x32x16_bf16 v[104:119], v[196:199], v[228:231], v[104:119]
    ds_read_b128 v[228:231], v8 offset:15360
    v_mul_f32 v122, v90, v122
    v_mul_f32 v123, v91, v123
    v_mul_f32 v124, v92, v124
    v_mul_f32 v125, v93, v125
    v_mul_f32 v126, v94, v126
    v_mul_f32 v127, v95, v127
    v_mul_f32 v128, v96, v128
    s_waitcnt lgkmcnt(3)
    v_mfma_f32_32x32x16_bf16 v[136:151], v[184:187], v[216:219], 0
    v_mul_f32 v129, v97, v129
    v_mul_f32 v130, v98, v130
    v_mul_f32 v131, v99, v131
    v_mul_f32 v132, v100, v132
    v_mul_f32 v133, v101, v133
    v_mul_f32 v134, v102, v134
    s_waitcnt lgkmcnt(2)
    v_mfma_f32_32x32x16_bf16 v[136:151], v[188:191], v[220:223], v[136:151]
    v_mul_f32 v135, v103, v135
    v_cvt_pk_bf16_f32 v88, v88, v89
    v_cvt_pk_bf16_f32 v89, v90, v91
    v_cvt_pk_bf16_f32 v90, v92, v93
    v_cvt_pk_bf16_f32 v91, v94, v95
    v_cvt_pk_bf16_f32 v92, v96, v97
    s_waitcnt lgkmcnt(1)
    v_mfma_f32_32x32x16_bf16 v[136:151], v[192:195], v[224:227], v[136:151]
    v_cvt_pk_bf16_f32 v93, v98, v99
    v_cvt_pk_bf16_f32 v94, v100, v101
    v_cvt_pk_bf16_f32 v95, v102, v103
    v_cvt_pk_bf16_f32 v120, v120, v121
    v_cvt_pk_bf16_f32 v121, v122, v123
    v_cvt_pk_bf16_f32 v122, v124, v125
    s_waitcnt lgkmcnt(0)
    v_mfma_f32_32x32x16_bf16 v[136:151], v[196:199], v[228:231], v[136:151]
    v_cvt_pk_bf16_f32 v123, v126, v127
    v_cvt_pk_bf16_f32 v124, v128, v129
    v_cvt_pk_bf16_f32 v125, v130, v131
    v_cvt_pk_bf16_f32 v126, v132, v133
    v_cvt_pk_bf16_f32 v127, v134, v135
    v_exp_f32 v104, v104
    ds_read_b128 v[216:219], v8
    v_exp_f32 v105, v105
    v_mfma_f32_32x32x16_bf16 v[24:39], v[208:211], v[88:91], v[24:39]
    ds_read_b128 v[220:223], v8 offset:1024
    v_exp_f32 v106, v106
    ds_read_b128 v[224:227], v8 offset:2048
    v_exp_f32 v107, v107
    ds_read_b128 v[228:231], v8 offset:3072
    v_exp_f32 v108, v108
    v_add_u32 v12, v18, v3
    v_exp_f32 v109, v109
    v_mfma_f32_32x32x16_bf16 v[24:39], v[212:215], v[92:95], v[24:39]
    buffer_load_dwordx4 v[184:187], v12, s[8:11], 0 offen
    buffer_load_dwordx4 v[188:191], v12, s[8:11], 0 offen offset:32
    buffer_load_dwordx4 v[192:195], v12, s[8:11], 0 offen offset:64
    buffer_load_dwordx4 v[196:199], v12, s[8:11], 0 offen offset:96
    v_exp_f32 v110, v110
    v_exp_f32 v111, v111
    v_exp_f32 v112, v112
    v_exp_f32 v113, v113
    v_mfma_f32_32x32x16_bf16 v[56:71], v[208:211], v[120:123], v[56:71]
    v_exp_f32 v114, v114
    v_exp_f32 v115, v115
    v_exp_f32 v116, v116
    v_exp_f32 v117, v117
    v_mfma_f32_32x32x16_bf16 v[56:71], v[212:215], v[124:127], v[56:71]
    v_exp_f32 v118, v118
    v_exp_f32 v119, v119
    v_add_f32 v104, 1.0, v104
    v_add_f32 v105, 1.0, v105
    v_add_f32 v106, 1.0, v106
    v_add_f32 v107, 1.0, v107
    v_mfma_f32_32x32x16_bf16 v[88:103], v[200:203], v[152:155], 0
    v_add_f32 v108, 1.0, v108
    v_add_f32 v109, 1.0, v109
    v_add_f32 v110, 1.0, v110
    v_add_f32 v111, 1.0, v111
    v_add_f32 v112, 1.0, v112
    v_add_f32 v113, 1.0, v113
    v_mfma_f32_32x32x16_bf16 v[88:103], v[204:207], v[156:159], v[88:103]
    v_add_f32 v114, 1.0, v114
    v_add_f32 v115, 1.0, v115
    v_add_f32 v116, 1.0, v116
    v_add_f32 v117, 1.0, v117
    v_add_f32 v118, 1.0, v118
    v_add_f32 v119, 1.0, v119
    s_waitcnt vmcnt(7) lgkmcnt(3)
    v_mfma_f32_32x32x16_bf16 v[88:103], v[168:171], v[216:219], v[88:103]
    ds_read_b128 v[216:219], v8 offset:8192
    v_rcp_f32 v104, v104
    v_rcp_f32 v105, v105
    v_rcp_f32 v106, v106
    v_rcp_f32 v107, v107
    v_rcp_f32 v108, v108
    v_rcp_f32 v109, v109
    s_waitcnt vmcnt(6) lgkmcnt(3)
    v_mfma_f32_32x32x16_bf16 v[88:103], v[172:175], v[220:223], v[88:103]
    ds_read_b128 v[220:223], v8 offset:9216
    v_rcp_f32 v110, v110
    v_rcp_f32 v111, v111
    v_rcp_f32 v112, v112
    v_rcp_f32 v113, v113
    v_rcp_f32 v114, v114
    v_rcp_f32 v115, v115
    s_waitcnt vmcnt(5) lgkmcnt(3)
    v_mfma_f32_32x32x16_bf16 v[88:103], v[176:179], v[224:227], v[88:103]
    ds_read_b128 v[224:227], v8 offset:10240
    v_rcp_f32 v116, v116
    v_rcp_f32 v117, v117
    v_rcp_f32 v118, v118
    v_rcp_f32 v119, v119
    v_mul_f32 v136, v104, v136
    v_mul_f32 v137, v105, v137
    s_waitcnt vmcnt(4) lgkmcnt(3)
    v_mfma_f32_32x32x16_bf16 v[88:103], v[180:183], v[228:231], v[88:103]
    ds_read_b128 v[228:231], v8 offset:11264
    v_mul_f32 v138, v106, v138
    v_mul_f32 v139, v107, v139
    v_mul_f32 v140, v108, v140
    v_mul_f32 v141, v109, v141
    v_mul_f32 v142, v110, v142
    v_mul_f32 v143, v111, v143
    v_mul_f32 v144, v112, v144
    s_waitcnt lgkmcnt(3)
    v_mfma_f32_32x32x16_bf16 v[120:135], v[168:171], v[216:219], 0
    v_mul_f32 v145, v113, v145
    v_mul_f32 v146, v114, v146
    v_mul_f32 v147, v115, v147
    v_mul_f32 v148, v116, v148
    v_mul_f32 v149, v117, v149
    v_mul_f32 v150, v118, v150
    s_waitcnt lgkmcnt(2)
    v_mfma_f32_32x32x16_bf16 v[120:135], v[172:175], v[220:223], v[120:135]
    v_mul_f32 v151, v119, v151
    v_cvt_pk_bf16_f32 v104, v104, v105
    v_cvt_pk_bf16_f32 v105, v106, v107
    v_cvt_pk_bf16_f32 v106, v108, v109
    v_cvt_pk_bf16_f32 v107, v110, v111
    v_cvt_pk_bf16_f32 v108, v112, v113
    s_waitcnt lgkmcnt(1)
    v_mfma_f32_32x32x16_bf16 v[120:135], v[176:179], v[224:227], v[120:135]
    v_cvt_pk_bf16_f32 v109, v114, v115
    v_cvt_pk_bf16_f32 v110, v116, v117
    v_cvt_pk_bf16_f32 v111, v118, v119
    v_cvt_pk_bf16_f32 v136, v136, v137
    v_cvt_pk_bf16_f32 v137, v138, v139
    v_cvt_pk_bf16_f32 v138, v140, v141
    s_waitcnt lgkmcnt(0)
    v_mfma_f32_32x32x16_bf16 v[120:135], v[180:183], v[228:231], v[120:135]
    v_cvt_pk_bf16_f32 v139, v142, v143
    v_cvt_pk_bf16_f32 v140, v144, v145
    v_cvt_pk_bf16_f32 v141, v146, v147
    v_cvt_pk_bf16_f32 v142, v148, v149
    v_cvt_pk_bf16_f32 v143, v150, v151
    s_add_u32 s41, s41, 1
    s_cmp_ge_u32 s41, s40
    s_cbranch_scc1 L_drain
    s_branch L_group
L_drain:
    s_setprio 0
    s_waitcnt vmcnt(0) lgkmcnt(0)
    v_mfma_f32_32x32x16_bf16 v[40:55], v[208:211], v[104:107], v[40:55]
    v_mfma_f32_32x32x16_bf16 v[40:55], v[212:215], v[108:111], v[40:55]
    v_mfma_f32_32x32x16_bf16 v[72:87], v[208:211], v[136:139], v[72:87]
    v_mfma_f32_32x32x16_bf16 v[72:87], v[212:215], v[140:143], v[72:87]
    s_nop 7
    s_nop 7
L_groups_done:
    s_add_u32 s38, s38, 512
    s_cmp_ge_u32 s38, s37
    s_cbranch_scc1 L_chunks_done
    s_mul_i32 s35, s53, 8000
    s_lshl_b32 s36, s51, 2
    s_add_u32 s35, s35, s36
    v_lshlrev_b32 v14, 5, v1
    v_mov_b32 v224, 0
    v_mov_b32 v225, 0
    v_mov_b32 v226, 0
    v_mov_b32 v227, 0
    buffer_load_dword v224, v14, s[20:23], s35 offen offset:0
    buffer_load_dword v225, v14, s[20:23], s35 offen offset:2048
    s_add_u32 s35, s35, 4096
    buffer_load_dword v226, v14, s[20:23], s35 offen offset:0
    s_add_u32 s35, s35, 2048
    v_cmp_gt_u32_e64 s[42:43], 58, v1
    s_mov_b64 exec, s[42:43]
    buffer_load_dword v227, v14, s[20:23], s35 offen offset:0
    s_mov_b64 exec, -1
    s_waitcnt vmcnt(0)
    s_branch L_chunk
L_chunks_done:
    v_and_b32 v2, 31, v0
    s_mul_i32 s35, s33, 3200
    v_lshlrev_b32 v14, 2, v2
    v_lshl_add_u32 v14, v3, 5, v14
    buffer_load_dword v120, v14, s[8:11], s35 offen offset:0
    buffer_load_dword v121, v14, s[8:11], s35 offen offset:128
    buffer_load_dword v122, v14, s[8:11], s35 offen offset:256
    buffer_load_dword v123, v14, s[8:11], s35 offen offset:384
    buffer_load_dword v124, v14, s[8:11], s35 offen offset:1024
    buffer_load_dword v125, v14, s[8:11], s35 offen offset:1152
    buffer_load_dword v126, v14, s[8:11], s35 offen offset:1280
    buffer_load_dword v127, v14, s[8:11], s35 offen offset:1408
    buffer_load_dword v128, v14, s[8:11], s35 offen offset:2048
    buffer_load_dword v129, v14, s[8:11], s35 offen offset:2176
    buffer_load_dword v130, v14, s[8:11], s35 offen offset:2304
    buffer_load_dword v131, v14, s[8:11], s35 offen offset:2432
    buffer_load_dword v132, v14, s[8:11], s35 offen offset:3072
    v_mov_b32 v13, 0x358637bd
    v_add_f32 v24, v13, v24
    v_add_f32 v40, v13, v40
    v_rcp_f32 v24, v24
    v_rcp_f32 v40, v40
    v_lshlrev_b32 v88, 16, v232
    v_and_b32 v104, 0xffff0000, v232
    v_fma_f32 v88, v56, v24, v88
    v_fma_f32 v104, v72, v40, v104
    v_cmp_lt_f32_e64 s[42:43], 0, v88
    v_cmp_lt_f32_e64 s[48:49], 0, v104
    v_mul_f32 v24, 0, v88
    v_mul_f32 v40, 0, v104
    v_cndmask_b32_e64 v88, v24, v88, s[42:43]
    v_cndmask_b32_e64 v104, v40, v104, s[48:49]
    v_add_f32 v25, v13, v25
    v_add_f32 v41, v13, v41
    v_rcp_f32 v25, v25
    v_rcp_f32 v41, v41
    v_lshlrev_b32 v89, 16, v233
    v_and_b32 v105, 0xffff0000, v233
    v_fma_f32 v89, v57, v25, v89
    v_fma_f32 v105, v73, v41, v105
    v_cmp_lt_f32_e64 s[42:43], 0, v89
    v_cmp_lt_f32_e64 s[48:49], 0, v105
    v_mul_f32 v25, 0, v89
    v_mul_f32 v41, 0, v105
    v_cndmask_b32_e64 v89, v25, v89, s[42:43]
    v_cndmask_b32_e64 v105, v41, v105, s[48:49]
    v_add_f32 v26, v13, v26
    v_add_f32 v42, v13, v42
    v_rcp_f32 v26, v26
    v_rcp_f32 v42, v42
    v_lshlrev_b32 v90, 16, v234
    v_and_b32 v106, 0xffff0000, v234
    v_fma_f32 v90, v58, v26, v90
    v_fma_f32 v106, v74, v42, v106
    v_cmp_lt_f32_e64 s[42:43], 0, v90
    v_cmp_lt_f32_e64 s[48:49], 0, v106
    v_mul_f32 v26, 0, v90
    v_mul_f32 v42, 0, v106
    v_cndmask_b32_e64 v90, v26, v90, s[42:43]
    v_cndmask_b32_e64 v106, v42, v106, s[48:49]
    v_add_f32 v27, v13, v27
    v_add_f32 v43, v13, v43
    v_rcp_f32 v27, v27
    v_rcp_f32 v43, v43
    v_lshlrev_b32 v91, 16, v235
    v_and_b32 v107, 0xffff0000, v235
    v_fma_f32 v91, v59, v27, v91
    v_fma_f32 v107, v75, v43, v107
    v_cmp_lt_f32_e64 s[42:43], 0, v91
    v_cmp_lt_f32_e64 s[48:49], 0, v107
    v_mul_f32 v27, 0, v91
    v_mul_f32 v43, 0, v107
    v_cndmask_b32_e64 v91, v27, v91, s[42:43]
    v_cndmask_b32_e64 v107, v43, v107, s[48:49]
    v_add_f32 v28, v13, v28
    v_add_f32 v44, v13, v44
    v_rcp_f32 v28, v28
    v_rcp_f32 v44, v44
    v_lshlrev_b32 v92, 16, v236
    v_and_b32 v108, 0xffff0000, v236
    v_fma_f32 v92, v60, v28, v92
    v_fma_f32 v108, v76, v44, v108
    v_cmp_lt_f32_e64 s[42:43], 0, v92
    v_cmp_lt_f32_e64 s[48:49], 0, v108
    v_mul_f32 v28, 0, v92
    v_mul_f32 v44, 0, v108
    v_cndmask_b32_e64 v92, v28, v92, s[42:43]
    v_cndmask_b32_e64 v108, v44, v108, s[48:49]
    v_add_f32 v29, v13, v29
    v_add_f32 v45, v13, v45
    v_rcp_f32 v29, v29
    v_rcp_f32 v45, v45
    v_lshlrev_b32 v93, 16, v237
    v_and_b32 v109, 0xffff0000, v237
    v_fma_f32 v93, v61, v29, v93
    v_fma_f32 v109, v77, v45, v109
    v_cmp_lt_f32_e64 s[42:43], 0, v93
    v_cmp_lt_f32_e64 s[48:49], 0, v109
    v_mul_f32 v29, 0, v93
    v_mul_f32 v45, 0, v109
    v_cndmask_b32_e64 v93, v29, v93, s[42:43]
    v_cndmask_b32_e64 v109, v45, v109, s[48:49]
    v_add_f32 v30, v13, v30
    v_add_f32 v46, v13, v46
    v_rcp_f32 v30, v30
    v_rcp_f32 v46, v46
    v_lshlrev_b32 v94, 16, v238
    v_and_b32 v110, 0xffff0000, v238
    v_fma_f32 v94, v62, v30, v94
    v_fma_f32 v110, v78, v46, v110
    v_cmp_lt_f32_e64 s[42:43], 0, v94
    v_cmp_lt_f32_e64 s[48:49], 0, v110
    v_mul_f32 v30, 0, v94
    v_mul_f32 v46, 0, v110
    v_cndmask_b32_e64 v94, v30, v94, s[42:43]
    v_cndmask_b32_e64 v110, v46, v110, s[48:49]
    v_add_f32 v31, v13, v31
    v_add_f32 v47, v13, v47
    v_rcp_f32 v31, v31
    v_rcp_f32 v47, v47
    v_lshlrev_b32 v95, 16, v239
    v_and_b32 v111, 0xffff0000, v239
    v_fma_f32 v95, v63, v31, v95
    v_fma_f32 v111, v79, v47, v111
    v_cmp_lt_f32_e64 s[42:43], 0, v95
    v_cmp_lt_f32_e64 s[48:49], 0, v111
    v_mul_f32 v31, 0, v95
    v_mul_f32 v47, 0, v111
    v_cndmask_b32_e64 v95, v31, v95, s[42:43]
    v_cndmask_b32_e64 v111, v47, v111, s[48:49]
    v_add_f32 v32, v13, v32
    v_add_f32 v48, v13, v48
    v_rcp_f32 v32, v32
    v_rcp_f32 v48, v48
    v_lshlrev_b32 v96, 16, v240
    v_and_b32 v112, 0xffff0000, v240
    v_fma_f32 v96, v64, v32, v96
    v_fma_f32 v112, v80, v48, v112
    v_cmp_lt_f32_e64 s[42:43], 0, v96
    v_cmp_lt_f32_e64 s[48:49], 0, v112
    v_mul_f32 v32, 0, v96
    v_mul_f32 v48, 0, v112
    v_cndmask_b32_e64 v96, v32, v96, s[42:43]
    v_cndmask_b32_e64 v112, v48, v112, s[48:49]
    v_add_f32 v33, v13, v33
    v_add_f32 v49, v13, v49
    v_rcp_f32 v33, v33
    v_rcp_f32 v49, v49
    v_lshlrev_b32 v97, 16, v241
    v_and_b32 v113, 0xffff0000, v241
    v_fma_f32 v97, v65, v33, v97
    v_fma_f32 v113, v81, v49, v113
    v_cmp_lt_f32_e64 s[42:43], 0, v97
    v_cmp_lt_f32_e64 s[48:49], 0, v113
    v_mul_f32 v33, 0, v97
    v_mul_f32 v49, 0, v113
    v_cndmask_b32_e64 v97, v33, v97, s[42:43]
    v_cndmask_b32_e64 v113, v49, v113, s[48:49]
    v_add_f32 v34, v13, v34
    v_add_f32 v50, v13, v50
    v_rcp_f32 v34, v34
    v_rcp_f32 v50, v50
    v_lshlrev_b32 v98, 16, v242
    v_and_b32 v114, 0xffff0000, v242
    v_fma_f32 v98, v66, v34, v98
    v_fma_f32 v114, v82, v50, v114
    v_cmp_lt_f32_e64 s[42:43], 0, v98
    v_cmp_lt_f32_e64 s[48:49], 0, v114
    v_mul_f32 v34, 0, v98
    v_mul_f32 v50, 0, v114
    v_cndmask_b32_e64 v98, v34, v98, s[42:43]
    v_cndmask_b32_e64 v114, v50, v114, s[48:49]
    v_add_f32 v35, v13, v35
    v_add_f32 v51, v13, v51
    v_rcp_f32 v35, v35
    v_rcp_f32 v51, v51
    v_lshlrev_b32 v99, 16, v243
    v_and_b32 v115, 0xffff0000, v243
    v_fma_f32 v99, v67, v35, v99
    v_fma_f32 v115, v83, v51, v115
    v_cmp_lt_f32_e64 s[42:43], 0, v99
    v_cmp_lt_f32_e64 s[48:49], 0, v115
    v_mul_f32 v35, 0, v99
    v_mul_f32 v51, 0, v115
    v_cndmask_b32_e64 v99, v35, v99, s[42:43]
    v_cndmask_b32_e64 v115, v51, v115, s[48:49]
    v_add_f32 v36, v13, v36
    v_add_f32 v52, v13, v52
    v_rcp_f32 v36, v36
    v_rcp_f32 v52, v52
    v_lshlrev_b32 v100, 16, v244
    v_and_b32 v116, 0xffff0000, v244
    v_fma_f32 v100, v68, v36, v100
    v_fma_f32 v116, v84, v52, v116
    v_cmp_lt_f32_e64 s[42:43], 0, v100
    v_cmp_lt_f32_e64 s[48:49], 0, v116
    v_mul_f32 v36, 0, v100
    v_mul_f32 v52, 0, v116
    v_cndmask_b32_e64 v100, v36, v100, s[42:43]
    v_cndmask_b32_e64 v116, v52, v116, s[48:49]
    s_waitcnt vmcnt(0)
    v_lshlrev_b32 v15, 16, v120
    v_and_b32 v120, 0xffff0000, v120
    v_add_f32 v15, v15, v88
    v_add_f32 v120, v120, v104
    v_cvt_pk_bf16_f32 v120, v15, v120
    v_lshlrev_b32 v15, 16, v121
    v_and_b32 v121, 0xffff0000, v121
    v_add_f32 v15, v15, v89
    v_add_f32 v121, v121, v105
    v_cvt_pk_bf16_f32 v121, v15, v121
    v_lshlrev_b32 v15, 16, v122
    v_and_b32 v122, 0xffff0000, v122
    v_add_f32 v15, v15, v90
    v_add_f32 v122, v122, v106
    v_cvt_pk_bf16_f32 v122, v15, v122
    v_lshlrev_b32 v15, 16, v123
    v_and_b32 v123, 0xffff0000, v123
    v_add_f32 v15, v15, v91
    v_add_f32 v123, v123, v107
    v_cvt_pk_bf16_f32 v123, v15, v123
    v_lshlrev_b32 v15, 16, v124
    v_and_b32 v124, 0xffff0000, v124
    v_add_f32 v15, v15, v92
    v_add_f32 v124, v124, v108
    v_cvt_pk_bf16_f32 v124, v15, v124
    v_lshlrev_b32 v15, 16, v125
    v_and_b32 v125, 0xffff0000, v125
    v_add_f32 v15, v15, v93
    v_add_f32 v125, v125, v109
    v_cvt_pk_bf16_f32 v125, v15, v125
    v_lshlrev_b32 v15, 16, v126
    v_and_b32 v126, 0xffff0000, v126
    v_add_f32 v15, v15, v94
    v_add_f32 v126, v126, v110
    v_cvt_pk_bf16_f32 v126, v15, v126
    v_lshlrev_b32 v15, 16, v127
    v_and_b32 v127, 0xffff0000, v127
    v_add_f32 v15, v15, v95
    v_add_f32 v127, v127, v111
    v_cvt_pk_bf16_f32 v127, v15, v127
    v_lshlrev_b32 v15, 16, v128
    v_and_b32 v128, 0xffff0000, v128
    v_add_f32 v15, v15, v96
    v_add_f32 v128, v128, v112
    v_cvt_pk_bf16_f32 v128, v15, v128
    v_lshlrev_b32 v15, 16, v129
    v_and_b32 v129, 0xffff0000, v129
    v_add_f32 v15, v15, v97
    v_add_f32 v129, v129, v113
    v_cvt_pk_bf16_f32 v129, v15, v129
    v_lshlrev_b32 v15, 16, v130
    v_and_b32 v130, 0xffff0000, v130
    v_add_f32 v15, v15, v98
    v_add_f32 v130, v130, v114
    v_cvt_pk_bf16_f32 v130, v15, v130
    v_lshlrev_b32 v15, 16, v131
    v_and_b32 v131, 0xffff0000, v131
    v_add_f32 v15, v15, v99
    v_add_f32 v131, v131, v115
    v_cvt_pk_bf16_f32 v131, v15, v131
    v_lshlrev_b32 v15, 16, v132
    v_and_b32 v132, 0xffff0000, v132
    v_add_f32 v15, v15, v100
    v_add_f32 v132, v132, v116
    v_cvt_pk_bf16_f32 v132, v15, v132
    buffer_store_dword v120, v14, s[12:15], s35 offen offset:0
    buffer_store_dword v121, v14, s[12:15], s35 offen offset:128
    buffer_store_dword v122, v14, s[12:15], s35 offen offset:256
    buffer_store_dword v123, v14, s[12:15], s35 offen offset:384
    buffer_store_dword v124, v14, s[12:15], s35 offen offset:1024
    buffer_store_dword v125, v14, s[12:15], s35 offen offset:1152
    buffer_store_dword v126, v14, s[12:15], s35 offen offset:1280
    buffer_store_dword v127, v14, s[12:15], s35 offen offset:1408
    buffer_store_dword v128, v14, s[12:15], s35 offen offset:2048
    buffer_store_dword v129, v14, s[12:15], s35 offen offset:2176
    buffer_store_dword v130, v14, s[12:15], s35 offen offset:2304
    buffer_store_dword v131, v14, s[12:15], s35 offen offset:2432
    s_mov_b64 exec, s[44:45]
    buffer_store_dword v132, v14, s[12:15], s35 offen offset:3072
L_main_end:
    s_endpgm
.section .rodata,"a"
.p2align 6
.amdhsa_kernel gs_partition_kernel
  .amdhsa_next_free_vgpr 176
  .amdhsa_next_free_sgpr 48
  .amdhsa_accum_offset 176
  .amdhsa_group_segment_fixed_size 0
  .amdhsa_kernarg_size 96
  .amdhsa_user_sgpr_count 2
  .amdhsa_user_sgpr_kernarg_segment_ptr 1
  .amdhsa_system_sgpr_workgroup_id_x 1
  .amdhsa_float_denorm_mode_32 3
.end_amdhsa_kernel
.p2align 6
.amdhsa_kernel gs_main_kernel
  .amdhsa_next_free_vgpr 245
  .amdhsa_next_free_sgpr 102
  .amdhsa_accum_offset 248
  .amdhsa_group_segment_fixed_size 0
  .amdhsa_kernarg_size 96
  .amdhsa_user_sgpr_count 2
  .amdhsa_user_sgpr_kernarg_segment_ptr 1
  .amdhsa_system_sgpr_workgroup_id_x 1
  .amdhsa_float_denorm_mode_32 3
.end_amdhsa_kernel
```
